```python
import torch

def _softmax(x, axis=-1):
    return torch.softmax(x, dim=axis)
def _gelu(x):
    return torch.nn.functional.gelu(x, approximate="tanh")
def _silu(x):
    return torch.nn.functional.silu(x)
def _sigmoid(x):
    return torch.sigmoid(x)
def _layernorm(x, axis=-1, eps=1e-5):
    m = x.mean(dim=axis, keepdim=True)
    v = x.var(dim=axis, keepdim=True, unbiased=False)
    return (x - m) / torch.sqrt(v + eps)
def _scatter_add(tgt, idx, src, axis=0):
    return tgt.clone().index_add_(axis, idx, src)
def _segment_sum(src, seg, n):
    out = torch.zeros((n,) + src.shape[1:], dtype=src.dtype)
    return out.index_add_(0, seg, src)
def _pad(x, pw):
    flat = tuple(v for pair in reversed(pw) for v in pair)
    return torch.nn.functional.pad(x, flat)

kernel_name = 'concat_heads__gqa_block_cached__mha_block_cached__near_ridge'

def setup_inputs():

    _w = (lambda a: (lambda t: t.to(torch.bfloat16) if t.is_floating_point() else t)(torch.as_tensor(a)))
    def _A_setup():
        B, Sq, D = 16, 32, 640
        Hq, Hkv, Sk, Dh = 32, 32, 32, 192
        assert Hq % Hkv == 0, (Hq, Hkv)
        return {
            "x": _w((lambda *s: torch.randn(*s, dtype=torch.bfloat16) * 0.8)(B, Sq, D)),
            "k_cache": _w((lambda *s: torch.randn(*s, dtype=torch.bfloat16) * 0.8)(B, Hkv, Sk, Dh)),
            "v_cache": _w((lambda *s: torch.randn(*s, dtype=torch.bfloat16) * 0.05)(B, Hkv, Sk, Dh)),
            "wq": _w((lambda *s: torch.randn(*s, dtype=torch.bfloat16) * 0.8)(D, Hq * Dh) * (D ** -0.5)),
            "wo": _w((lambda *s: torch.randn(*s, dtype=torch.bfloat16) * 0.05)(Hq * Dh, D) * ((Hq * Dh) ** -0.5)),
        }
    _A_in = _A_setup()

    def _B_setup():
        B, Sq, D = 16, 32, 640
        H, Sk, Dh = 32, 32, 192
        return {
            "x": _w((lambda *s: torch.randn(*s, dtype=torch.bfloat16) * 0.8)(B, Sq, D)),
            "k_cache": _w((lambda *s: torch.randn(*s, dtype=torch.bfloat16) * 0.8)(B, H, Sk, Dh)),
            "v_cache": _w((lambda *s: torch.randn(*s, dtype=torch.bfloat16) * 0.05)(B, H, Sk, Dh)),
            "wq": _w((lambda *s: torch.randn(*s, dtype=torch.bfloat16) * 0.8)(D, H * Dh) * (D ** -0.5)),
            "wo": _w((lambda *s: torch.randn(*s, dtype=torch.bfloat16) * 0.05)(H * Dh, D) * ((H * Dh) ** -0.5)),
        }
    _B_in = _B_setup()

    return {
        "A_x": _A_in["x"],
        "A_k_cache": _A_in["k_cache"],
        "A_v_cache": _A_in["v_cache"],
        "A_wq": _A_in["wq"],
        "A_wo": _A_in["wo"],
        "B_x": _B_in["x"],
        "B_k_cache": _B_in["k_cache"],
        "B_v_cache": _B_in["v_cache"],
        "B_wq": _B_in["wq"],
        "B_wo": _B_in["wo"],
    }

def reference(A_x, A_k_cache, A_v_cache, A_wq, A_wo, B_x, B_k_cache, B_v_cache, B_wq, B_wo):
    def _A_ref(x, k_cache, v_cache, wq, wo):
        B, Sq, D = x.shape
        Hq, Dh = 32, 192
        Hkv = k_cache.shape[1]
        rep = Hq // Hkv
        q = (lambda x, *d: x.permute(*d))((x @ wq).reshape(B, Sq, Hq, Dh), 0, 2, 1, 3)
        k = (lambda x, n, axis: torch.repeat_interleave(x, n, dim=axis))(k_cache, rep, axis=1)
        v = (lambda x, n, axis: torch.repeat_interleave(x, n, dim=axis))(v_cache, rep, axis=1)
        scores = torch.einsum("bhqd,bhkd->bhqk", q, k) * (Dh ** -0.5)
        p = _softmax(scores, axis=-1)
        o = torch.einsum("bhqk,bhkd->bhqd", p, v)
        return (lambda x, *d: x.permute(*d))(o, 0, 2, 1, 3).reshape(B, Sq, Hq * Dh) @ wo

    def _B_ref(x, k_cache, v_cache, wq, wo):
        B, Sq, D = x.shape
        H, Dh = 32, 192
        q = (lambda x, *d: x.permute(*d))((x @ wq).reshape(B, Sq, H, Dh), 0, 2, 1, 3)
        scores = torch.einsum("bhqd,bhkd->bhqk", q, k_cache) * (Dh ** -0.5)
        p = _softmax(scores, axis=-1)
        o = torch.einsum("bhqk,bhkd->bhqd", p, v_cache)
        return (lambda x, *d: x.permute(*d))(o, 0, 2, 1, 3).reshape(B, Sq, H * Dh) @ wo

    a = _A_ref(A_x, A_k_cache, A_v_cache, A_wq, A_wo)
    b = _B_ref(B_x, B_k_cache, B_v_cache, B_wq, B_wo)
    return torch.concatenate([a, b], axis=-1)
```

```asm
; @launch grid=(256,1,1) block=(512,1,1) lds=163840
.amdgcn_target "amdgcn-amd-amdhsa--gfx950"
.text
.p2align 8
.globl concat_heads__gqa_block_cached__mha_block_cached__near_ridge_kernel
.type concat_heads__gqa_block_cached__mha_block_cached__near_ridge_kernel,@function
concat_heads__gqa_block_cached__mha_block_cached__near_ridge_kernel:
    s_cmp_ge_u32 s2, 256
    s_cbranch_scc1 L_end
    s_and_b32 s3, s2, 7
    s_lshr_b32 s36, s3, 2
    s_mul_i32 s4, s36, 40
    s_load_dwordx8 s[8:15], s[0:1], s4
    s_add_u32 s4, s4, 32
    s_load_dwordx2 s[48:49], s[0:1], s4
    s_load_dwordx4 s[56:59], s[0:1], 80
    s_load_dwordx2 s[6:7], s[0:1], 96
    s_and_b32 s3, s3, 3
    s_lshl_b32 s3, s3, 3
    s_lshr_b32 s4, s2, 3
    s_and_b32 s5, s4, 7
    s_or_b32 s37, s3, s5
    s_lshr_b32 s38, s4, 3
    v_lshrrev_b32 v1, 6, v0
    s_nop 0
    v_readfirstlane_b32 s39, v1
    v_and_b32 v1, 63, v0
    s_lshr_b32 s40, s37, 2
    s_and_b32 s41, s37, 3
    s_nop 0
    s_cmp_lt_u32 s39, 4
    s_cbranch_scc1 L_compute
    s_sub_u32 s42, s39, 4
    v_lshrrev_b32 v2, 3, v1
    v_and_b32 v3, 7, v1
    v_lshrrev_b32 v4, 1, v2
    v_and_b32 v5, 1, v4
    v_lshlrev_b32 v5, 2, v5
    v_xor_b32 v5, v3, v5
    v_lshlrev_b32 v5, 4, v5
    s_mul_i32 s3, s37, 384
    s_mul_i32 s4, s42, 196608
    s_add_u32 s3, s3, s4
    s_mov_b32 s5, 12288
    v_mul_lo_u32 v6, v2, s5
    v_add_u32 v6, v6, v5
    v_add_u32 v8, s3, v6
    v_add_u32 v9, 0x18000, v8
    s_lshl_b32 s3, s38, 7
    s_lshl_b32 s4, s42, 5
    s_add_u32 s3, s3, s4
    s_mul_i32 s3, s3, 1280
    s_mov_b32 s5, 1280
    v_mul_lo_u32 v6, v2, s5
    v_add_u32 v6, s3, v6
    v_xor_b32 v5, v3, v4
    v_lshlrev_b32 v7, 4, v5
    v_xor_b32 v5, 4, v5
    v_lshlrev_b32 v5, 4, v5
    v_add_u32 v12, v6, v7
    v_add_u32 v13, v6, v5
    v_add_u32 v13, 0x2800, v13
    v_add_u32 v14, v6, v7
    v_add_u32 v14, 0x5000, v14
    v_add_u32 v15, v6, v5
    v_add_u32 v15, 0x7800, v15
    s_lshl_b32 s44, s42, 11
    s_lshl_b32 s45, s42, 12
    s_waitcnt lgkmcnt(0)
    s_mov_b32 s20, s14
    s_and_b32 s21, s15, 0xffff
    s_mov_b32 s22, 0x780000
    s_mov_b32 s23, 0x20000
    s_mov_b32 s16, s8
    s_and_b32 s17, s9, 0xffff
    s_mov_b32 s18, 0xa0000
    s_mov_b32 s19, 0x20000
    s_mov_b32 s46, 0x0
    s_mov_b32 s47, 0
    s_add_u32 m0, s44, 0x0
    s_nop 0
    buffer_load_dwordx4 v8, s[20:23], s46 offen lds
    s_add_u32 m0, s44, 0x1f80
    s_nop 0
    buffer_load_dwordx4 v8, s[20:23], s46 offen offset:128 lds
    s_add_u32 m0, s44, 0x3f00
    s_nop 0
    buffer_load_dwordx4 v8, s[20:23], s46 offen offset:256 lds
    s_add_u32 m0, s44, 0x400
    s_nop 0
    buffer_load_dwordx4 v9, s[20:23], s46 offen lds
    s_add_u32 m0, s44, 0x2380
    s_nop 0
    buffer_load_dwordx4 v9, s[20:23], s46 offen offset:128 lds
    s_add_u32 m0, s44, 0x4300
    s_nop 0
    buffer_load_dwordx4 v9, s[20:23], s46 offen offset:256 lds
    s_mov_b32 s28, s12
    s_and_b32 s29, s13, 0xffff
    s_mov_b32 s30, 0x600000
    s_mov_b32 s31, 0x20000
    s_mov_b32 s52, s48
    s_and_b32 s53, s49, 0xffff
    s_mov_b32 s54, 0x780000
    s_mov_b32 s55, 0x20000
    s_mov_b32 s32, s6
    s_and_b32 s33, s7, 0xffff
    s_mov_b32 s34, 0x1c04080
    s_mov_b32 s35, 0x20000
    s_mov_b32 s60, s58
    s_and_b32 s61, s59, 0xffff
    s_mov_b32 s62, 0x100
    s_mov_b32 s63, 0x20000
    s_mov_b32 s56, s56
    s_and_b32 s57, s57, 0xffff
    s_mov_b32 s58, 0x140000
    s_mov_b32 s59, 0x20000
    s_mov_b32 s5, 3277
    s_mul_i32 s3, s40, 983040
    s_mul_i32 s4, s41, 320
    s_add_u32 s3, s3, s4
    s_mul_i32 s4, s42, 20480
    s_add_u32 s3, s3, s4
    s_mov_b32 s4, 1280
    v_add_u32 v2, 0, v1
    v_mul_lo_u32 v3, v2, s5
    v_lshrrev_b32 v3, 16, v3
    v_mul_u32_u24 v4, 20, v3
    v_sub_u32 v4, v2, v4
    v_mul_lo_u32 v3, v3, s4
    v_lshl_add_u32 v3, v4, 4, v3
    v_add_u32 v16, s3, v3
    v_add_u32 v2, 64, v1
    v_mul_lo_u32 v3, v2, s5
    v_lshrrev_b32 v3, 16, v3
    v_mul_u32_u24 v4, 20, v3
    v_sub_u32 v4, v2, v4
    v_mul_lo_u32 v3, v3, s4
    v_lshl_add_u32 v3, v4, 4, v3
    v_add_u32 v17, s3, v3
    v_add_u32 v2, 128, v1
    v_mul_lo_u32 v3, v2, s5
    v_lshrrev_b32 v3, 16, v3
    v_mul_u32_u24 v4, 20, v3
    v_sub_u32 v4, v2, v4
    v_mul_lo_u32 v3, v3, s4
    v_lshl_add_u32 v3, v4, 4, v3
    v_add_u32 v18, s3, v3
    v_add_u32 v2, 192, v1
    v_mul_lo_u32 v3, v2, s5
    v_lshrrev_b32 v3, 16, v3
    v_mul_u32_u24 v4, 20, v3
    v_sub_u32 v4, v2, v4
    v_mul_lo_u32 v3, v3, s4
    v_lshl_add_u32 v3, v4, 4, v3
    v_add_u32 v19, s3, v3
    v_add_u32 v2, 256, v1
    v_mul_lo_u32 v3, v2, s5
    v_lshrrev_b32 v3, 16, v3
    v_mul_u32_u24 v4, 20, v3
    v_sub_u32 v4, v2, v4
    v_mul_lo_u32 v3, v3, s4
    v_lshl_add_u32 v3, v4, 4, v3
    v_add_u32 v20, s3, v3
    v_lshrrev_b32 v2, 3, v1
    v_and_b32 v3, 7, v1
    v_lshrrev_b32 v4, 1, v2
    v_xor_b32 v5, v3, v4
    v_lshlrev_b32 v7, 4, v5
    v_xor_b32 v5, 4, v5
    v_lshlrev_b32 v5, 4, v5
    v_mul_u32_u24 v6, 384, v2
    s_lshl_b32 s3, s38, 2
    s_add_u32 s3, s3, s42
    s_lshl_b32 s3, s3, 5
    s_lshl_b32 s4, s40, 2
    s_add_u32 s3, s3, s4
    s_mul_i32 s3, s3, 12288
    v_add_u32 v6, s3, v6
    v_add_u32 v21, v6, v7
    v_add_u32 v22, v6, v5
    v_add_u32 v22, 0xc00, v22
    v_add_u32 v23, v6, v7
    v_add_u32 v23, 0x1800, v23
    v_add_u32 v24, v6, v5
    v_add_u32 v24, 0x2400, v24
    s_mul_i32 s50, s42, 5120
    s_waitcnt vmcnt(0)
    s_barrier
    s_mov_b32 s46, 0x180000
    s_mov_b32 s47, 256
    s_add_u32 m0, s44, 0x14000
    s_nop 0
    buffer_load_dwordx4 v8, s[20:23], s46 offen lds
    s_add_u32 m0, s44, 0x15f80
    s_nop 0
    buffer_load_dwordx4 v8, s[20:23], s46 offen offset:128 lds
    s_add_u32 m0, s44, 0x17f00
    s_nop 0
    buffer_load_dwordx4 v8, s[20:23], s46 offen offset:256 lds
    s_add_u32 m0, s44, 0x14400
    s_nop 0
    buffer_load_dwordx4 v9, s[20:23], s46 offen lds
    s_add_u32 m0, s44, 0x16380
    s_nop 0
    buffer_load_dwordx4 v9, s[20:23], s46 offen offset:128 lds
    s_add_u32 m0, s44, 0x18300
    s_nop 0
    buffer_load_dwordx4 v9, s[20:23], s46 offen offset:256 lds
    s_add_u32 m0, s45, 0x1a000
    s_nop 0
    buffer_load_dwordx4 v12, s[16:19], s47 offen lds
    s_add_u32 m0, s45, 0x1a400
    s_nop 0
    buffer_load_dwordx4 v13, s[16:19], s47 offen lds
    s_add_u32 m0, s45, 0x1a800
    s_nop 0
    buffer_load_dwordx4 v14, s[16:19], s47 offen lds
    s_add_u32 m0, s45, 0x1ac00
    s_nop 0
    buffer_load_dwordx4 v15, s[16:19], s47 offen lds
    s_mov_b32 s24, s10
    s_and_b32 s25, s11, 0xffff
    s_mov_b32 s26, 0x600000
    s_mov_b32 s27, 0x20000
    s_mov_b32 s5, 3277
    s_lshl_b32 s3, s38, 2
    s_add_u32 s3, s3, s42
    s_lshl_b32 s3, s3, 5
    s_add_u32 s3, s3, s37
    s_mul_i32 s3, s3, 12288
    v_add_u32 v2, 0, v1
    v_mul_lo_u32 v3, v2, s5
    v_lshrrev_b32 v3, 16, v3
    v_mul_u32_u24 v4, 20, v3
    v_sub_u32 v4, v2, v4
    v_bfe_u32 v5, v3, 2, 2
    v_xor_b32 v4, v4, v5
    v_mul_u32_u24 v3, 384, v3
    v_lshl_add_u32 v3, v4, 4, v3
    v_add_u32 v32, s3, v3
    v_add_u32 v2, 64, v1
    v_mul_lo_u32 v3, v2, s5
    v_lshrrev_b32 v3, 16, v3
    v_mul_u32_u24 v4, 20, v3
    v_sub_u32 v4, v2, v4
    v_bfe_u32 v5, v3, 2, 2
    v_xor_b32 v4, v4, v5
    v_mul_u32_u24 v3, 384, v3
    v_lshl_add_u32 v3, v4, 4, v3
    v_add_u32 v33, s3, v3
    v_add_u32 v2, 128, v1
    v_mul_lo_u32 v3, v2, s5
    v_lshrrev_b32 v3, 16, v3
    v_mul_u32_u24 v4, 20, v3
    v_sub_u32 v4, v2, v4
    v_bfe_u32 v5, v3, 2, 2
    v_xor_b32 v4, v4, v5
    v_mul_u32_u24 v3, 384, v3
    v_lshl_add_u32 v3, v4, 4, v3
    v_add_u32 v34, s3, v3
    v_add_u32 v2, 192, v1
    v_mul_lo_u32 v3, v2, s5
    v_lshrrev_b32 v3, 16, v3
    v_mul_u32_u24 v4, 20, v3
    v_sub_u32 v4, v2, v4
    v_bfe_u32 v5, v3, 2, 2
    v_xor_b32 v4, v4, v5
    v_mul_u32_u24 v3, 384, v3
    v_lshl_add_u32 v3, v4, 4, v3
    v_add_u32 v35, s3, v3
    v_add_u32 v2, 256, v1
    v_mul_lo_u32 v3, v2, s5
    v_lshrrev_b32 v3, 16, v3
    v_mul_u32_u24 v4, 20, v3
    v_sub_u32 v4, v2, v4
    v_bfe_u32 v5, v3, 2, 2
    v_xor_b32 v4, v4, v5
    v_mul_u32_u24 v3, 384, v3
    v_lshl_add_u32 v3, v4, 4, v3
    v_add_u32 v36, s3, v3
    s_mul_i32 s51, s42, 10240
    s_mov_b32 s46, 6144
    s_add_u32 m0, s51, 0x1e000
    s_nop 0
    buffer_load_dwordx4 v32, s[24:27], 0 offen lds
    s_add_u32 m0, s51, 0x1e400
    s_nop 0
    buffer_load_dwordx4 v33, s[24:27], 0 offen lds
    s_add_u32 m0, s51, 0x1e800
    s_nop 0
    buffer_load_dwordx4 v34, s[24:27], 0 offen lds
    s_add_u32 m0, s51, 0x1ec00
    s_nop 0
    buffer_load_dwordx4 v35, s[24:27], 0 offen lds
    s_add_u32 m0, s51, 0x1f000
    s_nop 0
    buffer_load_dwordx4 v36, s[24:27], 0 offen lds
    s_add_u32 m0, s51, 0x1f400
    s_nop 0
    buffer_load_dwordx4 v32, s[24:27], s46 offen lds
    s_add_u32 m0, s51, 0x1f800
    s_nop 0
    buffer_load_dwordx4 v33, s[24:27], s46 offen lds
    s_add_u32 m0, s51, 0x1fc00
    s_nop 0
    buffer_load_dwordx4 v34, s[24:27], s46 offen lds
    s_add_u32 m0, s51, 0x20000
    s_nop 0
    buffer_load_dwordx4 v35, s[24:27], s46 offen lds
    s_add_u32 m0, s51, 0x20400
    s_nop 0
    buffer_load_dwordx4 v36, s[24:27], s46 offen lds
    s_barrier
    s_mov_b32 s46, 0x240000
    s_mov_b32 s47, 384
    s_add_u32 m0, s44, 0x0
    s_nop 0
    buffer_load_dwordx4 v8, s[20:23], s46 offen lds
    s_add_u32 m0, s44, 0x1f80
    s_nop 0
    buffer_load_dwordx4 v8, s[20:23], s46 offen offset:128 lds
    s_add_u32 m0, s44, 0x3f00
    s_nop 0
    buffer_load_dwordx4 v8, s[20:23], s46 offen offset:256 lds
    s_add_u32 m0, s44, 0x400
    s_nop 0
    buffer_load_dwordx4 v9, s[20:23], s46 offen lds
    s_add_u32 m0, s44, 0x2380
    s_nop 0
    buffer_load_dwordx4 v9, s[20:23], s46 offen offset:128 lds
    s_add_u32 m0, s44, 0x4300
    s_nop 0
    buffer_load_dwordx4 v9, s[20:23], s46 offen offset:256 lds
    s_add_u32 m0, s45, 0x6000
    s_nop 0
    buffer_load_dwordx4 v12, s[16:19], s47 offen lds
    s_add_u32 m0, s45, 0x6400
    s_nop 0
    buffer_load_dwordx4 v13, s[16:19], s47 offen lds
    s_add_u32 m0, s45, 0x6800
    s_nop 0
    buffer_load_dwordx4 v14, s[16:19], s47 offen lds
    s_add_u32 m0, s45, 0x6c00
    s_nop 0
    buffer_load_dwordx4 v15, s[16:19], s47 offen lds
    s_waitcnt vmcnt(20)
    s_barrier
    s_mov_b32 s46, 0x300000
    s_mov_b32 s47, 512
    s_add_u32 m0, s44, 0xa000
    s_nop 0
    buffer_load_dwordx4 v8, s[20:23], s46 offen lds
    s_add_u32 m0, s44, 0xbf80
    s_nop 0
    buffer_load_dwordx4 v8, s[20:23], s46 offen offset:128 lds
    s_add_u32 m0, s44, 0xdf00
    s_nop 0
    buffer_load_dwordx4 v8, s[20:23], s46 offen offset:256 lds
    s_add_u32 m0, s44, 0xa400
    s_nop 0
    buffer_load_dwordx4 v9, s[20:23], s46 offen lds
    s_add_u32 m0, s44, 0xc380
    s_nop 0
    buffer_load_dwordx4 v9, s[20:23], s46 offen offset:128 lds
    s_add_u32 m0, s44, 0xe300
    s_nop 0
    buffer_load_dwordx4 v9, s[20:23], s46 offen offset:256 lds
    s_add_u32 m0, s45, 0x10000
    s_nop 0
    buffer_load_dwordx4 v12, s[16:19], s47 offen lds
    s_add_u32 m0, s45, 0x10400
    s_nop 0
    buffer_load_dwordx4 v13, s[16:19], s47 offen lds
    s_add_u32 m0, s45, 0x10800
    s_nop 0
    buffer_load_dwordx4 v14, s[16:19], s47 offen lds
    s_add_u32 m0, s45, 0x10c00
    s_nop 0
    buffer_load_dwordx4 v15, s[16:19], s47 offen lds
    s_waitcnt vmcnt(10)
    s_barrier
    s_mov_b32 s46, 0x3c0000
    s_mov_b32 s47, 640
    s_add_u32 m0, s44, 0x14000
    s_nop 0
    buffer_load_dwordx4 v8, s[20:23], s46 offen lds
    s_add_u32 m0, s44, 0x15f80
    s_nop 0
    buffer_load_dwordx4 v8, s[20:23], s46 offen offset:128 lds
    s_add_u32 m0, s44, 0x17f00
    s_nop 0
    buffer_load_dwordx4 v8, s[20:23], s46 offen offset:256 lds
    s_add_u32 m0, s44, 0x14400
    s_nop 0
    buffer_load_dwordx4 v9, s[20:23], s46 offen lds
    s_add_u32 m0, s44, 0x16380
    s_nop 0
    buffer_load_dwordx4 v9, s[20:23], s46 offen offset:128 lds
    s_add_u32 m0, s44, 0x18300
    s_nop 0
    buffer_load_dwordx4 v9, s[20:23], s46 offen offset:256 lds
    s_add_u32 m0, s45, 0x1a000
    s_nop 0
    buffer_load_dwordx4 v12, s[16:19], s47 offen lds
    s_add_u32 m0, s45, 0x1a400
    s_nop 0
    buffer_load_dwordx4 v13, s[16:19], s47 offen lds
    s_add_u32 m0, s45, 0x1a800
    s_nop 0
    buffer_load_dwordx4 v14, s[16:19], s47 offen lds
    s_add_u32 m0, s45, 0x1ac00
    s_nop 0
    buffer_load_dwordx4 v15, s[16:19], s47 offen lds
    s_waitcnt vmcnt(10)
    s_barrier
    s_mov_b32 s46, 0x480000
    s_mov_b32 s47, 768
    s_add_u32 m0, s44, 0x0
    s_nop 0
    buffer_load_dwordx4 v8, s[20:23], s46 offen lds
    s_add_u32 m0, s44, 0x1f80
    s_nop 0
    buffer_load_dwordx4 v8, s[20:23], s46 offen offset:128 lds
    s_add_u32 m0, s44, 0x3f00
    s_nop 0
    buffer_load_dwordx4 v8, s[20:23], s46 offen offset:256 lds
    s_add_u32 m0, s44, 0x400
    s_nop 0
    buffer_load_dwordx4 v9, s[20:23], s46 offen lds
    s_add_u32 m0, s44, 0x2380
    s_nop 0
    buffer_load_dwordx4 v9, s[20:23], s46 offen offset:128 lds
    s_add_u32 m0, s44, 0x4300
    s_nop 0
    buffer_load_dwordx4 v9, s[20:23], s46 offen offset:256 lds
    s_add_u32 m0, s45, 0x6000
    s_nop 0
    buffer_load_dwordx4 v12, s[16:19], s47 offen lds
    s_add_u32 m0, s45, 0x6400
    s_nop 0
    buffer_load_dwordx4 v13, s[16:19], s47 offen lds
    s_add_u32 m0, s45, 0x6800
    s_nop 0
    buffer_load_dwordx4 v14, s[16:19], s47 offen lds
    s_add_u32 m0, s45, 0x6c00
    s_nop 0
    buffer_load_dwordx4 v15, s[16:19], s47 offen lds
    s_mov_b32 s46, 0x540000
    s_mov_b32 s47, 896
    s_add_u32 m0, s44, 0x1e000
    s_nop 0
    buffer_load_dwordx4 v8, s[20:23], s46 offen lds
    s_add_u32 m0, s44, 0x1ff80
    s_nop 0
    buffer_load_dwordx4 v8, s[20:23], s46 offen offset:128 lds
    s_add_u32 m0, s44, 0x21f00
    s_nop 0
    buffer_load_dwordx4 v8, s[20:23], s46 offen offset:256 lds
    s_add_u32 m0, s44, 0x1e400
    s_nop 0
    buffer_load_dwordx4 v9, s[20:23], s46 offen lds
    s_add_u32 m0, s44, 0x20380
    s_nop 0
    buffer_load_dwordx4 v9, s[20:23], s46 offen offset:128 lds
    s_add_u32 m0, s44, 0x22300
    s_nop 0
    buffer_load_dwordx4 v9, s[20:23], s46 offen offset:256 lds
    s_add_u32 m0, s45, 0x24000
    s_nop 0
    buffer_load_dwordx4 v12, s[16:19], s47 offen lds
    s_add_u32 m0, s45, 0x24400
    s_nop 0
    buffer_load_dwordx4 v13, s[16:19], s47 offen lds
    s_add_u32 m0, s45, 0x24800
    s_nop 0
    buffer_load_dwordx4 v14, s[16:19], s47 offen lds
    s_add_u32 m0, s45, 0x24c00
    s_nop 0
    buffer_load_dwordx4 v15, s[16:19], s47 offen lds
    s_waitcnt vmcnt(20)
    s_barrier
    s_mov_b32 s46, 0x600000
    s_mov_b32 s47, 1024
    s_add_u32 m0, s44, 0xa000
    s_nop 0
    buffer_load_dwordx4 v8, s[20:23], s46 offen lds
    s_add_u32 m0, s44, 0xbf80
    s_nop 0
    buffer_load_dwordx4 v8, s[20:23], s46 offen offset:128 lds
    s_add_u32 m0, s44, 0xdf00
    s_nop 0
    buffer_load_dwordx4 v8, s[20:23], s46 offen offset:256 lds
    s_add_u32 m0, s44, 0xa400
    s_nop 0
    buffer_load_dwordx4 v9, s[20:23], s46 offen lds
    s_add_u32 m0, s44, 0xc380
    s_nop 0
    buffer_load_dwordx4 v9, s[20:23], s46 offen offset:128 lds
    s_add_u32 m0, s44, 0xe300
    s_nop 0
    buffer_load_dwordx4 v9, s[20:23], s46 offen offset:256 lds
    s_add_u32 m0, s45, 0x10000
    s_nop 0
    buffer_load_dwordx4 v12, s[16:19], s47 offen lds
    s_add_u32 m0, s45, 0x10400
    s_nop 0
    buffer_load_dwordx4 v13, s[16:19], s47 offen lds
    s_add_u32 m0, s45, 0x10800
    s_nop 0
    buffer_load_dwordx4 v14, s[16:19], s47 offen lds
    s_add_u32 m0, s45, 0x10c00
    s_nop 0
    buffer_load_dwordx4 v15, s[16:19], s47 offen lds
    s_waitcnt vmcnt(20)
    s_barrier
    s_mov_b32 s46, 0x6c0000
    s_mov_b32 s47, 1152
    s_add_u32 m0, s44, 0x14000
    s_nop 0
    buffer_load_dwordx4 v8, s[20:23], s46 offen lds
    s_add_u32 m0, s44, 0x15f80
    s_nop 0
    buffer_load_dwordx4 v8, s[20:23], s46 offen offset:128 lds
    s_add_u32 m0, s44, 0x17f00
    s_nop 0
    buffer_load_dwordx4 v8, s[20:23], s46 offen offset:256 lds
    s_add_u32 m0, s44, 0x14400
    s_nop 0
    buffer_load_dwordx4 v9, s[20:23], s46 offen lds
    s_add_u32 m0, s44, 0x16380
    s_nop 0
    buffer_load_dwordx4 v9, s[20:23], s46 offen offset:128 lds
    s_add_u32 m0, s44, 0x18300
    s_nop 0
    buffer_load_dwordx4 v9, s[20:23], s46 offen offset:256 lds
    s_add_u32 m0, s45, 0x1a000
    s_nop 0
    buffer_load_dwordx4 v12, s[16:19], s47 offen lds
    s_add_u32 m0, s45, 0x1a400
    s_nop 0
    buffer_load_dwordx4 v13, s[16:19], s47 offen lds
    s_add_u32 m0, s45, 0x1a800
    s_nop 0
    buffer_load_dwordx4 v14, s[16:19], s47 offen lds
    s_add_u32 m0, s45, 0x1ac00
    s_nop 0
    buffer_load_dwordx4 v15, s[16:19], s47 offen lds
    s_waitcnt vmcnt(20)
    s_barrier
    s_add_u32 s3, s41, 0
    s_and_b32 s3, s3, 3
    s_mul_i32 s46, s3, 245760
    s_mul_i32 s47, s3, 12288
    s_add_u32 s3, s38, 0
    s_cmp_ge_u32 s3, 3
    s_cselect_b32 s4, 3, 0
    s_sub_u32 s3, s3, s4
    s_cmp_ge_u32 s3, 3
    s_cselect_b32 s4, 3, 0
    s_sub_u32 s3, s3, s4
    s_mul_i32 s4, s3, 81920
    s_add_u32 s46, s46, s4
    s_lshl_b32 s4, s3, 7
    s_add_u32 s47, s47, s4
    s_add_u32 m0, s50, 0x0
    s_nop 0
    buffer_load_dwordx4 v16, s[52:55], s46 offen lds
    s_add_u32 m0, s50, 0x400
    s_nop 0
    buffer_load_dwordx4 v17, s[52:55], s46 offen lds
    s_add_u32 m0, s50, 0x800
    s_nop 0
    buffer_load_dwordx4 v18, s[52:55], s46 offen lds
    s_add_u32 m0, s50, 0xc00
    s_nop 0
    buffer_load_dwordx4 v19, s[52:55], s46 offen lds
    s_add_u32 m0, s50, 0x1000
    s_nop 0
    buffer_load_dwordx4 v20, s[52:55], s46 offen lds
    s_add_u32 m0, s45, 0x5000
    s_nop 0
    buffer_load_dwordx4 v21, s[28:31], s47 offen lds
    s_add_u32 m0, s45, 0x5400
    s_nop 0
    buffer_load_dwordx4 v22, s[28:31], s47 offen lds
    s_add_u32 m0, s45, 0x5800
    s_nop 0
    buffer_load_dwordx4 v23, s[28:31], s47 offen lds
    s_add_u32 m0, s45, 0x5c00
    s_nop 0
    buffer_load_dwordx4 v24, s[28:31], s47 offen lds
    s_waitcnt vmcnt(19)
    s_barrier
    s_add_u32 s3, s41, 0
    s_and_b32 s3, s3, 3
    s_mul_i32 s46, s3, 245760
    s_mul_i32 s47, s3, 12288
    s_add_u32 s3, s38, 1
    s_cmp_ge_u32 s3, 3
    s_cselect_b32 s4, 3, 0
    s_sub_u32 s3, s3, s4
    s_cmp_ge_u32 s3, 3
    s_cselect_b32 s4, 3, 0
    s_sub_u32 s3, s3, s4
    s_mul_i32 s4, s3, 81920
    s_add_u32 s46, s46, s4
    s_lshl_b32 s4, s3, 7
    s_add_u32 s47, s47, s4
    s_add_u32 m0, s50, 0x1e000
    s_nop 0
    buffer_load_dwordx4 v16, s[52:55], s46 offen lds
    s_add_u32 m0, s50, 0x1e400
    s_nop 0
    buffer_load_dwordx4 v17, s[52:55], s46 offen lds
    s_add_u32 m0, s50, 0x1e800
    s_nop 0
    buffer_load_dwordx4 v18, s[52:55], s46 offen lds
    s_add_u32 m0, s50, 0x1ec00
    s_nop 0
    buffer_load_dwordx4 v19, s[52:55], s46 offen lds
    s_add_u32 m0, s50, 0x1f000
    s_nop 0
    buffer_load_dwordx4 v20, s[52:55], s46 offen lds
    s_add_u32 m0, s45, 0x23000
    s_nop 0
    buffer_load_dwordx4 v21, s[28:31], s47 offen lds
    s_add_u32 m0, s45, 0x23400
    s_nop 0
    buffer_load_dwordx4 v22, s[28:31], s47 offen lds
    s_add_u32 m0, s45, 0x23800
    s_nop 0
    buffer_load_dwordx4 v23, s[28:31], s47 offen lds
    s_add_u32 m0, s45, 0x23c00
    s_nop 0
    buffer_load_dwordx4 v24, s[28:31], s47 offen lds
    s_waitcnt vmcnt(18)
    s_barrier
    s_add_u32 s3, s41, 0
    s_and_b32 s3, s3, 3
    s_mul_i32 s46, s3, 245760
    s_mul_i32 s47, s3, 12288
    s_add_u32 s3, s38, 2
    s_cmp_ge_u32 s3, 3
    s_cselect_b32 s4, 3, 0
    s_sub_u32 s3, s3, s4
    s_cmp_ge_u32 s3, 3
    s_cselect_b32 s4, 3, 0
    s_sub_u32 s3, s3, s4
    s_mul_i32 s4, s3, 81920
    s_add_u32 s46, s46, s4
    s_lshl_b32 s4, s3, 7
    s_add_u32 s47, s47, s4
    s_add_u32 m0, s50, 0xa000
    s_nop 0
    buffer_load_dwordx4 v16, s[52:55], s46 offen lds
    s_add_u32 m0, s50, 0xa400
    s_nop 0
    buffer_load_dwordx4 v17, s[52:55], s46 offen lds
    s_add_u32 m0, s50, 0xa800
    s_nop 0
    buffer_load_dwordx4 v18, s[52:55], s46 offen lds
    s_add_u32 m0, s50, 0xac00
    s_nop 0
    buffer_load_dwordx4 v19, s[52:55], s46 offen lds
    s_add_u32 m0, s50, 0xb000
    s_nop 0
    buffer_load_dwordx4 v20, s[52:55], s46 offen lds
    s_add_u32 m0, s45, 0xf000
    s_nop 0
    buffer_load_dwordx4 v21, s[28:31], s47 offen lds
    s_add_u32 m0, s45, 0xf400
    s_nop 0
    buffer_load_dwordx4 v22, s[28:31], s47 offen lds
    s_add_u32 m0, s45, 0xf800
    s_nop 0
    buffer_load_dwordx4 v23, s[28:31], s47 offen lds
    s_add_u32 m0, s45, 0xfc00
    s_nop 0
    buffer_load_dwordx4 v24, s[28:31], s47 offen lds
    s_waitcnt vmcnt(18)
    s_barrier
    s_add_u32 s3, s41, 1
    s_and_b32 s3, s3, 3
    s_mul_i32 s46, s3, 245760
    s_mul_i32 s47, s3, 12288
    s_add_u32 s3, s38, 0
    s_cmp_ge_u32 s3, 3
    s_cselect_b32 s4, 3, 0
    s_sub_u32 s3, s3, s4
    s_cmp_ge_u32 s3, 3
    s_cselect_b32 s4, 3, 0
    s_sub_u32 s3, s3, s4
    s_mul_i32 s4, s3, 81920
    s_add_u32 s46, s46, s4
    s_lshl_b32 s4, s3, 7
    s_add_u32 s47, s47, s4
    s_add_u32 m0, s50, 0x14000
    s_nop 0
    buffer_load_dwordx4 v16, s[52:55], s46 offen lds
    s_add_u32 m0, s50, 0x14400
    s_nop 0
    buffer_load_dwordx4 v17, s[52:55], s46 offen lds
    s_add_u32 m0, s50, 0x14800
    s_nop 0
    buffer_load_dwordx4 v18, s[52:55], s46 offen lds
    s_add_u32 m0, s50, 0x14c00
    s_nop 0
    buffer_load_dwordx4 v19, s[52:55], s46 offen lds
    s_add_u32 m0, s50, 0x15000
    s_nop 0
    buffer_load_dwordx4 v20, s[52:55], s46 offen lds
    s_add_u32 m0, s45, 0x19000
    s_nop 0
    buffer_load_dwordx4 v21, s[28:31], s47 offen lds
    s_add_u32 m0, s45, 0x19400
    s_nop 0
    buffer_load_dwordx4 v22, s[28:31], s47 offen lds
    s_add_u32 m0, s45, 0x19800
    s_nop 0
    buffer_load_dwordx4 v23, s[28:31], s47 offen lds
    s_add_u32 m0, s45, 0x19c00
    s_nop 0
    buffer_load_dwordx4 v24, s[28:31], s47 offen lds
    s_waitcnt vmcnt(18)
    s_barrier
    s_add_u32 s3, s41, 1
    s_and_b32 s3, s3, 3
    s_mul_i32 s46, s3, 245760
    s_mul_i32 s47, s3, 12288
    s_add_u32 s3, s38, 1
    s_cmp_ge_u32 s3, 3
    s_cselect_b32 s4, 3, 0
    s_sub_u32 s3, s3, s4
    s_cmp_ge_u32 s3, 3
    s_cselect_b32 s4, 3, 0
    s_sub_u32 s3, s3, s4
    s_mul_i32 s4, s3, 81920
    s_add_u32 s46, s46, s4
    s_lshl_b32 s4, s3, 7
    s_add_u32 s47, s47, s4
    s_add_u32 m0, s50, 0x0
    s_nop 0
    buffer_load_dwordx4 v16, s[52:55], s46 offen lds
    s_add_u32 m0, s50, 0x400
    s_nop 0
    buffer_load_dwordx4 v17, s[52:55], s46 offen lds
    s_add_u32 m0, s50, 0x800
    s_nop 0
    buffer_load_dwordx4 v18, s[52:55], s46 offen lds
    s_add_u32 m0, s50, 0xc00
    s_nop 0
    buffer_load_dwordx4 v19, s[52:55], s46 offen lds
    s_add_u32 m0, s50, 0x1000
    s_nop 0
    buffer_load_dwordx4 v20, s[52:55], s46 offen lds
    s_add_u32 m0, s45, 0x5000
    s_nop 0
    buffer_load_dwordx4 v21, s[28:31], s47 offen lds
    s_add_u32 m0, s45, 0x5400
    s_nop 0
    buffer_load_dwordx4 v22, s[28:31], s47 offen lds
    s_add_u32 m0, s45, 0x5800
    s_nop 0
    buffer_load_dwordx4 v23, s[28:31], s47 offen lds
    s_add_u32 m0, s45, 0x5c00
    s_nop 0
    buffer_load_dwordx4 v24, s[28:31], s47 offen lds
    s_waitcnt vmcnt(18)
    s_barrier
    s_add_u32 s3, s41, 1
    s_and_b32 s3, s3, 3
    s_mul_i32 s46, s3, 245760
    s_mul_i32 s47, s3, 12288
    s_add_u32 s3, s38, 2
    s_cmp_ge_u32 s3, 3
    s_cselect_b32 s4, 3, 0
    s_sub_u32 s3, s3, s4
    s_cmp_ge_u32 s3, 3
    s_cselect_b32 s4, 3, 0
    s_sub_u32 s3, s3, s4
    s_mul_i32 s4, s3, 81920
    s_add_u32 s46, s46, s4
    s_lshl_b32 s4, s3, 7
    s_add_u32 s47, s47, s4
    s_add_u32 m0, s50, 0x1e000
    s_nop 0
    buffer_load_dwordx4 v16, s[52:55], s46 offen lds
    s_add_u32 m0, s50, 0x1e400
    s_nop 0
    buffer_load_dwordx4 v17, s[52:55], s46 offen lds
    s_add_u32 m0, s50, 0x1e800
    s_nop 0
    buffer_load_dwordx4 v18, s[52:55], s46 offen lds
    s_add_u32 m0, s50, 0x1ec00
    s_nop 0
    buffer_load_dwordx4 v19, s[52:55], s46 offen lds
    s_add_u32 m0, s50, 0x1f000
    s_nop 0
    buffer_load_dwordx4 v20, s[52:55], s46 offen lds
    s_add_u32 m0, s45, 0x23000
    s_nop 0
    buffer_load_dwordx4 v21, s[28:31], s47 offen lds
    s_add_u32 m0, s45, 0x23400
    s_nop 0
    buffer_load_dwordx4 v22, s[28:31], s47 offen lds
    s_add_u32 m0, s45, 0x23800
    s_nop 0
    buffer_load_dwordx4 v23, s[28:31], s47 offen lds
    s_add_u32 m0, s45, 0x23c00
    s_nop 0
    buffer_load_dwordx4 v24, s[28:31], s47 offen lds
    s_waitcnt vmcnt(18)
    s_barrier
    s_add_u32 s3, s41, 2
    s_and_b32 s3, s3, 3
    s_mul_i32 s46, s3, 245760
    s_mul_i32 s47, s3, 12288
    s_add_u32 s3, s38, 0
    s_cmp_ge_u32 s3, 3
    s_cselect_b32 s4, 3, 0
    s_sub_u32 s3, s3, s4
    s_cmp_ge_u32 s3, 3
    s_cselect_b32 s4, 3, 0
    s_sub_u32 s3, s3, s4
    s_mul_i32 s4, s3, 81920
    s_add_u32 s46, s46, s4
    s_lshl_b32 s4, s3, 7
    s_add_u32 s47, s47, s4
    s_add_u32 m0, s50, 0xa000
    s_nop 0
    buffer_load_dwordx4 v16, s[52:55], s46 offen lds
    s_add_u32 m0, s50, 0xa400
    s_nop 0
    buffer_load_dwordx4 v17, s[52:55], s46 offen lds
    s_add_u32 m0, s50, 0xa800
    s_nop 0
    buffer_load_dwordx4 v18, s[52:55], s46 offen lds
    s_add_u32 m0, s50, 0xac00
    s_nop 0
    buffer_load_dwordx4 v19, s[52:55], s46 offen lds
    s_add_u32 m0, s50, 0xb000
    s_nop 0
    buffer_load_dwordx4 v20, s[52:55], s46 offen lds
    s_add_u32 m0, s45, 0xf000
    s_nop 0
    buffer_load_dwordx4 v21, s[28:31], s47 offen lds
    s_add_u32 m0, s45, 0xf400
    s_nop 0
    buffer_load_dwordx4 v22, s[28:31], s47 offen lds
    s_add_u32 m0, s45, 0xf800
    s_nop 0
    buffer_load_dwordx4 v23, s[28:31], s47 offen lds
    s_add_u32 m0, s45, 0xfc00
    s_nop 0
    buffer_load_dwordx4 v24, s[28:31], s47 offen lds
    s_waitcnt vmcnt(18)
    s_barrier
    s_add_u32 s3, s41, 2
    s_and_b32 s3, s3, 3
    s_mul_i32 s46, s3, 245760
    s_mul_i32 s47, s3, 12288
    s_add_u32 s3, s38, 1
    s_cmp_ge_u32 s3, 3
    s_cselect_b32 s4, 3, 0
    s_sub_u32 s3, s3, s4
    s_cmp_ge_u32 s3, 3
    s_cselect_b32 s4, 3, 0
    s_sub_u32 s3, s3, s4
    s_mul_i32 s4, s3, 81920
    s_add_u32 s46, s46, s4
    s_lshl_b32 s4, s3, 7
    s_add_u32 s47, s47, s4
    s_add_u32 m0, s50, 0x14000
    s_nop 0
    buffer_load_dwordx4 v16, s[52:55], s46 offen lds
    s_add_u32 m0, s50, 0x14400
    s_nop 0
    buffer_load_dwordx4 v17, s[52:55], s46 offen lds
    s_add_u32 m0, s50, 0x14800
    s_nop 0
    buffer_load_dwordx4 v18, s[52:55], s46 offen lds
    s_add_u32 m0, s50, 0x14c00
    s_nop 0
    buffer_load_dwordx4 v19, s[52:55], s46 offen lds
    s_add_u32 m0, s50, 0x15000
    s_nop 0
    buffer_load_dwordx4 v20, s[52:55], s46 offen lds
    s_add_u32 m0, s45, 0x19000
    s_nop 0
    buffer_load_dwordx4 v21, s[28:31], s47 offen lds
    s_add_u32 m0, s45, 0x19400
    s_nop 0
    buffer_load_dwordx4 v22, s[28:31], s47 offen lds
    s_add_u32 m0, s45, 0x19800
    s_nop 0
    buffer_load_dwordx4 v23, s[28:31], s47 offen lds
    s_add_u32 m0, s45, 0x19c00
    s_nop 0
    buffer_load_dwordx4 v24, s[28:31], s47 offen lds
    s_waitcnt vmcnt(18)
    s_barrier
    s_add_u32 s3, s41, 2
    s_and_b32 s3, s3, 3
    s_mul_i32 s46, s3, 245760
    s_mul_i32 s47, s3, 12288
    s_add_u32 s3, s38, 2
    s_cmp_ge_u32 s3, 3
    s_cselect_b32 s4, 3, 0
    s_sub_u32 s3, s3, s4
    s_cmp_ge_u32 s3, 3
    s_cselect_b32 s4, 3, 0
    s_sub_u32 s3, s3, s4
    s_mul_i32 s4, s3, 81920
    s_add_u32 s46, s46, s4
    s_lshl_b32 s4, s3, 7
    s_add_u32 s47, s47, s4
    s_add_u32 m0, s50, 0x0
    s_nop 0
    buffer_load_dwordx4 v16, s[52:55], s46 offen lds
    s_add_u32 m0, s50, 0x400
    s_nop 0
    buffer_load_dwordx4 v17, s[52:55], s46 offen lds
    s_add_u32 m0, s50, 0x800
    s_nop 0
    buffer_load_dwordx4 v18, s[52:55], s46 offen lds
    s_add_u32 m0, s50, 0xc00
    s_nop 0
    buffer_load_dwordx4 v19, s[52:55], s46 offen lds
    s_add_u32 m0, s50, 0x1000
    s_nop 0
    buffer_load_dwordx4 v20, s[52:55], s46 offen lds
    s_add_u32 m0, s45, 0x5000
    s_nop 0
    buffer_load_dwordx4 v21, s[28:31], s47 offen lds
    s_add_u32 m0, s45, 0x5400
    s_nop 0
    buffer_load_dwordx4 v22, s[28:31], s47 offen lds
    s_add_u32 m0, s45, 0x5800
    s_nop 0
    buffer_load_dwordx4 v23, s[28:31], s47 offen lds
    s_add_u32 m0, s45, 0x5c00
    s_nop 0
    buffer_load_dwordx4 v24, s[28:31], s47 offen lds
    s_waitcnt vmcnt(18)
    s_barrier
    s_add_u32 s3, s41, 3
    s_and_b32 s3, s3, 3
    s_mul_i32 s46, s3, 245760
    s_mul_i32 s47, s3, 12288
    s_add_u32 s3, s38, 0
    s_cmp_ge_u32 s3, 3
    s_cselect_b32 s4, 3, 0
    s_sub_u32 s3, s3, s4
    s_cmp_ge_u32 s3, 3
    s_cselect_b32 s4, 3, 0
    s_sub_u32 s3, s3, s4
    s_mul_i32 s4, s3, 81920
    s_add_u32 s46, s46, s4
    s_lshl_b32 s4, s3, 7
    s_add_u32 s47, s47, s4
    s_add_u32 m0, s50, 0x1e000
    s_nop 0
    buffer_load_dwordx4 v16, s[52:55], s46 offen lds
    s_add_u32 m0, s50, 0x1e400
    s_nop 0
    buffer_load_dwordx4 v17, s[52:55], s46 offen lds
    s_add_u32 m0, s50, 0x1e800
    s_nop 0
    buffer_load_dwordx4 v18, s[52:55], s46 offen lds
    s_add_u32 m0, s50, 0x1ec00
    s_nop 0
    buffer_load_dwordx4 v19, s[52:55], s46 offen lds
    s_add_u32 m0, s50, 0x1f000
    s_nop 0
    buffer_load_dwordx4 v20, s[52:55], s46 offen lds
    s_add_u32 m0, s45, 0x23000
    s_nop 0
    buffer_load_dwordx4 v21, s[28:31], s47 offen lds
    s_add_u32 m0, s45, 0x23400
    s_nop 0
    buffer_load_dwordx4 v22, s[28:31], s47 offen lds
    s_add_u32 m0, s45, 0x23800
    s_nop 0
    buffer_load_dwordx4 v23, s[28:31], s47 offen lds
    s_add_u32 m0, s45, 0x23c00
    s_nop 0
    buffer_load_dwordx4 v24, s[28:31], s47 offen lds
    s_waitcnt vmcnt(18)
    s_barrier
    s_add_u32 s3, s41, 3
    s_and_b32 s3, s3, 3
    s_mul_i32 s46, s3, 245760
    s_mul_i32 s47, s3, 12288
    s_add_u32 s3, s38, 1
    s_cmp_ge_u32 s3, 3
    s_cselect_b32 s4, 3, 0
    s_sub_u32 s3, s3, s4
    s_cmp_ge_u32 s3, 3
    s_cselect_b32 s4, 3, 0
    s_sub_u32 s3, s3, s4
    s_mul_i32 s4, s3, 81920
    s_add_u32 s46, s46, s4
    s_lshl_b32 s4, s3, 7
    s_add_u32 s47, s47, s4
    s_add_u32 m0, s50, 0xa000
    s_nop 0
    buffer_load_dwordx4 v16, s[52:55], s46 offen lds
    s_add_u32 m0, s50, 0xa400
    s_nop 0
    buffer_load_dwordx4 v17, s[52:55], s46 offen lds
    s_add_u32 m0, s50, 0xa800
    s_nop 0
    buffer_load_dwordx4 v18, s[52:55], s46 offen lds
    s_add_u32 m0, s50, 0xac00
    s_nop 0
    buffer_load_dwordx4 v19, s[52:55], s46 offen lds
    s_add_u32 m0, s50, 0xb000
    s_nop 0
    buffer_load_dwordx4 v20, s[52:55], s46 offen lds
    s_add_u32 m0, s45, 0xf000
    s_nop 0
    buffer_load_dwordx4 v21, s[28:31], s47 offen lds
    s_add_u32 m0, s45, 0xf400
    s_nop 0
    buffer_load_dwordx4 v22, s[28:31], s47 offen lds
    s_add_u32 m0, s45, 0xf800
    s_nop 0
    buffer_load_dwordx4 v23, s[28:31], s47 offen lds
    s_add_u32 m0, s45, 0xfc00
    s_nop 0
    buffer_load_dwordx4 v24, s[28:31], s47 offen lds
    s_waitcnt vmcnt(18)
    s_barrier
    s_add_u32 s3, s41, 3
    s_and_b32 s3, s3, 3
    s_mul_i32 s46, s3, 245760
    s_mul_i32 s47, s3, 12288
    s_add_u32 s3, s38, 2
    s_cmp_ge_u32 s3, 3
    s_cselect_b32 s4, 3, 0
    s_sub_u32 s3, s3, s4
    s_cmp_ge_u32 s3, 3
    s_cselect_b32 s4, 3, 0
    s_sub_u32 s3, s3, s4
    s_mul_i32 s4, s3, 81920
    s_add_u32 s46, s46, s4
    s_lshl_b32 s4, s3, 7
    s_add_u32 s47, s47, s4
    s_add_u32 m0, s50, 0x14000
    s_nop 0
    buffer_load_dwordx4 v16, s[52:55], s46 offen lds
    s_add_u32 m0, s50, 0x14400
    s_nop 0
    buffer_load_dwordx4 v17, s[52:55], s46 offen lds
    s_add_u32 m0, s50, 0x14800
    s_nop 0
    buffer_load_dwordx4 v18, s[52:55], s46 offen lds
    s_add_u32 m0, s50, 0x14c00
    s_nop 0
    buffer_load_dwordx4 v19, s[52:55], s46 offen lds
    s_add_u32 m0, s50, 0x15000
    s_nop 0
    buffer_load_dwordx4 v20, s[52:55], s46 offen lds
    s_add_u32 m0, s45, 0x19000
    s_nop 0
    buffer_load_dwordx4 v21, s[28:31], s47 offen lds
    s_add_u32 m0, s45, 0x19400
    s_nop 0
    buffer_load_dwordx4 v22, s[28:31], s47 offen lds
    s_add_u32 m0, s45, 0x19800
    s_nop 0
    buffer_load_dwordx4 v23, s[28:31], s47 offen lds
    s_add_u32 m0, s45, 0x19c00
    s_nop 0
    buffer_load_dwordx4 v24, s[28:31], s47 offen lds
    s_waitcnt vmcnt(18)
    s_barrier
    s_waitcnt vmcnt(9)
    s_barrier
    s_waitcnt vmcnt(0)
    s_barrier
    s_mov_b32 s51, 0
nonce_ld:
    v_mov_b32 v2, 0
    buffer_load_dword v2, v2, s[60:63], 0 offen sc1
    s_waitcnt vmcnt(0)
    v_readfirstlane_b32 s43, v2
    s_add_u32 s51, s51, 1
    s_cmp_gt_u32 s51, 200000
    s_cbranch_scc1 nonce_ld_done
    s_nop 0
    s_cmp_eq_u32 s43, 0
    s_cbranch_scc1 nonce_ld
nonce_ld_done:
    s_lshl_b32 s3, s36, 2
    s_add_u32 s3, s3, s38
    s_lshl_b32 s3, s3, 2
    s_add_u32 s3, s3, s41
    s_lshr_b32 s4, s40, 1
    s_lshl_b32 s5, s3, 2
    s_add_u32 s5, s5, s4
    s_lshl_b32 s5, s5, 7
    s_add_u32 s44, s5, 0x1c00000
    s_and_b32 s5, s40, 1
    s_mul_i32 s5, s5, 5
    s_add_u32 s45, s5, s42
    s_mul_i32 s46, s3, 327680
    s_mul_i32 s47, s4, 10240
    s_add_u32 s46, s46, s47
    s_add_u32 s46, s46, 0x1000000
    s_lshl_b32 s47, s38, 2
    s_add_u32 s47, s47, s4
    s_mul_i32 s47, s47, 81920
    s_mul_i32 s3, s36, 1280
    s_add_u32 s47, s47, s3
    s_mul_i32 s3, s41, 320
    s_add_u32 s47, s47, s3
    v_and_b32 v2, 31, v1
    v_mul_u32_u24 v2, 2560, v2
    v_lshrrev_b32 v3, 5, v1
    v_lshl_add_u32 v2, v3, 4, v2
    v_and_b32 v4, 7, v1
    v_lshlrev_b32 v4, 2, v4
    v_lshlrev_b32 v30, 4, v1
    s_barrier
    s_mov_b32 s50, 0
L_pollP:
    buffer_load_dword v5, v4, s[32:35], s44 offen sc1
    s_waitcnt vmcnt(0)
    v_cmp_ne_u32 vcc, s43, v5
    s_add_u32 s50, s50, 1
    s_cmp_gt_u32 s50, 200000
    s_cbranch_scc1 L_pollP_done
    s_nop 0
    s_cmp_lg_u64 vcc, 0
    s_cbranch_scc1 L_pollP
L_pollP_done:
    s_cmp_eq_u32 s42, 0
    s_cbranch_scc1 L_red2
    s_lshl_b32 s3, s45, 10
    s_add_u32 s3, s3, s46
    buffer_load_dwordx4 v[64:67], v30, s[32:35], s3 offen sc1
    s_add_u32 s3, s3, 40960
    buffer_load_dwordx4 v[68:71], v30, s[32:35], s3 offen sc1
    s_add_u32 s3, s3, 40960
    buffer_load_dwordx4 v[72:75], v30, s[32:35], s3 offen sc1
    s_add_u32 s3, s3, 40960
    buffer_load_dwordx4 v[76:79], v30, s[32:35], s3 offen sc1
    s_add_u32 s3, s3, 40960
    buffer_load_dwordx4 v[80:83], v30, s[32:35], s3 offen sc1
    s_add_u32 s3, s3, 40960
    buffer_load_dwordx4 v[84:87], v30, s[32:35], s3 offen sc1
    s_add_u32 s3, s3, 40960
    buffer_load_dwordx4 v[88:91], v30, s[32:35], s3 offen sc1
    s_add_u32 s3, s3, 40960
    buffer_load_dwordx4 v[92:95], v30, s[32:35], s3 offen sc1
    s_waitcnt vmcnt(7)
    v_lshlrev_b32 v8, 16, v64
    v_and_b32 v9, 0xffff0000, v64
    v_lshlrev_b32 v10, 16, v65
    v_and_b32 v11, 0xffff0000, v65
    v_lshlrev_b32 v12, 16, v66
    v_and_b32 v13, 0xffff0000, v66
    v_lshlrev_b32 v14, 16, v67
    v_and_b32 v15, 0xffff0000, v67
    s_waitcnt vmcnt(6)
    v_lshlrev_b32 v16, 16, v68
    v_and_b32 v17, 0xffff0000, v68
    v_add_f32 v8, v8, v16
    v_add_f32 v9, v9, v17
    v_lshlrev_b32 v16, 16, v69
    v_and_b32 v17, 0xffff0000, v69
    v_add_f32 v10, v10, v16
    v_add_f32 v11, v11, v17
    v_lshlrev_b32 v16, 16, v70
    v_and_b32 v17, 0xffff0000, v70
    v_add_f32 v12, v12, v16
    v_add_f32 v13, v13, v17
    v_lshlrev_b32 v16, 16, v71
    v_and_b32 v17, 0xffff0000, v71
    v_add_f32 v14, v14, v16
    v_add_f32 v15, v15, v17
    s_waitcnt vmcnt(5)
    v_lshlrev_b32 v16, 16, v72
    v_and_b32 v17, 0xffff0000, v72
    v_add_f32 v8, v8, v16
    v_add_f32 v9, v9, v17
    v_lshlrev_b32 v16, 16, v73
    v_and_b32 v17, 0xffff0000, v73
    v_add_f32 v10, v10, v16
    v_add_f32 v11, v11, v17
    v_lshlrev_b32 v16, 16, v74
    v_and_b32 v17, 0xffff0000, v74
    v_add_f32 v12, v12, v16
    v_add_f32 v13, v13, v17
    v_lshlrev_b32 v16, 16, v75
    v_and_b32 v17, 0xffff0000, v75
    v_add_f32 v14, v14, v16
    v_add_f32 v15, v15, v17
    s_waitcnt vmcnt(4)
    v_lshlrev_b32 v16, 16, v76
    v_and_b32 v17, 0xffff0000, v76
    v_add_f32 v8, v8, v16
    v_add_f32 v9, v9, v17
    v_lshlrev_b32 v16, 16, v77
    v_and_b32 v17, 0xffff0000, v77
    v_add_f32 v10, v10, v16
    v_add_f32 v11, v11, v17
    v_lshlrev_b32 v16, 16, v78
    v_and_b32 v17, 0xffff0000, v78
    v_add_f32 v12, v12, v16
    v_add_f32 v13, v13, v17
    v_lshlrev_b32 v16, 16, v79
    v_and_b32 v17, 0xffff0000, v79
    v_add_f32 v14, v14, v16
    v_add_f32 v15, v15, v17
    s_waitcnt vmcnt(3)
    v_lshlrev_b32 v16, 16, v80
    v_and_b32 v17, 0xffff0000, v80
    v_add_f32 v8, v8, v16
    v_add_f32 v9, v9, v17
    v_lshlrev_b32 v16, 16, v81
    v_and_b32 v17, 0xffff0000, v81
    v_add_f32 v10, v10, v16
    v_add_f32 v11, v11, v17
    v_lshlrev_b32 v16, 16, v82
    v_and_b32 v17, 0xffff0000, v82
    v_add_f32 v12, v12, v16
    v_add_f32 v13, v13, v17
    v_lshlrev_b32 v16, 16, v83
    v_and_b32 v17, 0xffff0000, v83
    v_add_f32 v14, v14, v16
    v_add_f32 v15, v15, v17
    s_waitcnt vmcnt(2)
    v_lshlrev_b32 v16, 16, v84
    v_and_b32 v17, 0xffff0000, v84
    v_add_f32 v8, v8, v16
    v_add_f32 v9, v9, v17
    v_lshlrev_b32 v16, 16, v85
    v_and_b32 v17, 0xffff0000, v85
    v_add_f32 v10, v10, v16
    v_add_f32 v11, v11, v17
    v_lshlrev_b32 v16, 16, v86
    v_and_b32 v17, 0xffff0000, v86
    v_add_f32 v12, v12, v16
    v_add_f32 v13, v13, v17
    v_lshlrev_b32 v16, 16, v87
    v_and_b32 v17, 0xffff0000, v87
    v_add_f32 v14, v14, v16
    v_add_f32 v15, v15, v17
    s_waitcnt vmcnt(1)
    v_lshlrev_b32 v16, 16, v88
    v_and_b32 v17, 0xffff0000, v88
    v_add_f32 v8, v8, v16
    v_add_f32 v9, v9, v17
    v_lshlrev_b32 v16, 16, v89
    v_and_b32 v17, 0xffff0000, v89
    v_add_f32 v10, v10, v16
    v_add_f32 v11, v11, v17
    v_lshlrev_b32 v16, 16, v90
    v_and_b32 v17, 0xffff0000, v90
    v_add_f32 v12, v12, v16
    v_add_f32 v13, v13, v17
    v_lshlrev_b32 v16, 16, v91
    v_and_b32 v17, 0xffff0000, v91
    v_add_f32 v14, v14, v16
    v_add_f32 v15, v15, v17
    s_waitcnt vmcnt(0)
    v_lshlrev_b32 v16, 16, v92
    v_and_b32 v17, 0xffff0000, v92
    v_add_f32 v8, v8, v16
    v_add_f32 v9, v9, v17
    v_lshlrev_b32 v16, 16, v93
    v_and_b32 v17, 0xffff0000, v93
    v_add_f32 v10, v10, v16
    v_add_f32 v11, v11, v17
    v_lshlrev_b32 v16, 16, v94
    v_and_b32 v17, 0xffff0000, v94
    v_add_f32 v12, v12, v16
    v_add_f32 v13, v13, v17
    v_lshlrev_b32 v16, 16, v95
    v_and_b32 v17, 0xffff0000, v95
    v_add_f32 v14, v14, v16
    v_add_f32 v15, v15, v17
    v_cvt_pk_bf16_f32 v24, v8, v9
    v_cvt_pk_bf16_f32 v25, v10, v11
    v_cvt_pk_bf16_f32 v26, v12, v13
    v_cvt_pk_bf16_f32 v27, v14, v15
    s_lshl_b32 s3, s45, 5
    s_add_u32 s3, s3, s47
    buffer_store_dwordx4 v[24:27], v2, s[56:59], s3 offen
    s_branch L_red_done
L_red2:
    s_add_u32 s50, s45, 4
    s_lshl_b32 s3, s45, 10
    s_add_u32 s3, s3, s46
    buffer_load_dwordx4 v[64:67], v30, s[32:35], s3 offen sc1
    s_add_u32 s3, s3, 40960
    buffer_load_dwordx4 v[68:71], v30, s[32:35], s3 offen sc1
    s_add_u32 s3, s3, 40960
    buffer_load_dwordx4 v[72:75], v30, s[32:35], s3 offen sc1
    s_add_u32 s3, s3, 40960
    buffer_load_dwordx4 v[76:79], v30, s[32:35], s3 offen sc1
    s_add_u32 s3, s3, 40960
    buffer_load_dwordx4 v[80:83], v30, s[32:35], s3 offen sc1
    s_add_u32 s3, s3, 40960
    buffer_load_dwordx4 v[84:87], v30, s[32:35], s3 offen sc1
    s_add_u32 s3, s3, 40960
    buffer_load_dwordx4 v[88:91], v30, s[32:35], s3 offen sc1
    s_add_u32 s3, s3, 40960
    buffer_load_dwordx4 v[92:95], v30, s[32:35], s3 offen sc1
    s_lshl_b32 s3, s50, 10
    s_add_u32 s3, s3, s46
    buffer_load_dwordx4 v[96:99], v30, s[32:35], s3 offen sc1
    s_add_u32 s3, s3, 40960
    buffer_load_dwordx4 v[100:103], v30, s[32:35], s3 offen sc1
    s_add_u32 s3, s3, 40960
    buffer_load_dwordx4 v[104:107], v30, s[32:35], s3 offen sc1
    s_add_u32 s3, s3, 40960
    buffer_load_dwordx4 v[108:111], v30, s[32:35], s3 offen sc1
    s_add_u32 s3, s3, 40960
    buffer_load_dwordx4 v[112:115], v30, s[32:35], s3 offen sc1
    s_add_u32 s3, s3, 40960
    buffer_load_dwordx4 v[116:119], v30, s[32:35], s3 offen sc1
    s_add_u32 s3, s3, 40960
    buffer_load_dwordx4 v[120:123], v30, s[32:35], s3 offen sc1
    s_add_u32 s3, s3, 40960
    buffer_load_dwordx4 v[124:127], v30, s[32:35], s3 offen sc1
    s_waitcnt vmcnt(15)
    v_lshlrev_b32 v8, 16, v64
    v_and_b32 v9, 0xffff0000, v64
    v_lshlrev_b32 v10, 16, v65
    v_and_b32 v11, 0xffff0000, v65
    v_lshlrev_b32 v12, 16, v66
    v_and_b32 v13, 0xffff0000, v66
    v_lshlrev_b32 v14, 16, v67
    v_and_b32 v15, 0xffff0000, v67
    s_waitcnt vmcnt(14)
    v_lshlrev_b32 v16, 16, v68
    v_and_b32 v17, 0xffff0000, v68
    v_add_f32 v8, v8, v16
    v_add_f32 v9, v9, v17
    v_lshlrev_b32 v16, 16, v69
    v_and_b32 v17, 0xffff0000, v69
    v_add_f32 v10, v10, v16
    v_add_f32 v11, v11, v17
    v_lshlrev_b32 v16, 16, v70
    v_and_b32 v17, 0xffff0000, v70
    v_add_f32 v12, v12, v16
    v_add_f32 v13, v13, v17
    v_lshlrev_b32 v16, 16, v71
    v_and_b32 v17, 0xffff0000, v71
    v_add_f32 v14, v14, v16
    v_add_f32 v15, v15, v17
    s_waitcnt vmcnt(13)
    v_lshlrev_b32 v16, 16, v72
    v_and_b32 v17, 0xffff0000, v72
    v_add_f32 v8, v8, v16
    v_add_f32 v9, v9, v17
    v_lshlrev_b32 v16, 16, v73
    v_and_b32 v17, 0xffff0000, v73
    v_add_f32 v10, v10, v16
    v_add_f32 v11, v11, v17
    v_lshlrev_b32 v16, 16, v74
    v_and_b32 v17, 0xffff0000, v74
    v_add_f32 v12, v12, v16
    v_add_f32 v13, v13, v17
    v_lshlrev_b32 v16, 16, v75
    v_and_b32 v17, 0xffff0000, v75
    v_add_f32 v14, v14, v16
    v_add_f32 v15, v15, v17
    s_waitcnt vmcnt(12)
    v_lshlrev_b32 v16, 16, v76
    v_and_b32 v17, 0xffff0000, v76
    v_add_f32 v8, v8, v16
    v_add_f32 v9, v9, v17
    v_lshlrev_b32 v16, 16, v77
    v_and_b32 v17, 0xffff0000, v77
    v_add_f32 v10, v10, v16
    v_add_f32 v11, v11, v17
    v_lshlrev_b32 v16, 16, v78
    v_and_b32 v17, 0xffff0000, v78
    v_add_f32 v12, v12, v16
    v_add_f32 v13, v13, v17
    v_lshlrev_b32 v16, 16, v79
    v_and_b32 v17, 0xffff0000, v79
    v_add_f32 v14, v14, v16
    v_add_f32 v15, v15, v17
    s_waitcnt vmcnt(11)
    v_lshlrev_b32 v16, 16, v80
    v_and_b32 v17, 0xffff0000, v80
    v_add_f32 v8, v8, v16
    v_add_f32 v9, v9, v17
    v_lshlrev_b32 v16, 16, v81
    v_and_b32 v17, 0xffff0000, v81
    v_add_f32 v10, v10, v16
    v_add_f32 v11, v11, v17
    v_lshlrev_b32 v16, 16, v82
    v_and_b32 v17, 0xffff0000, v82
    v_add_f32 v12, v12, v16
    v_add_f32 v13, v13, v17
    v_lshlrev_b32 v16, 16, v83
    v_and_b32 v17, 0xffff0000, v83
    v_add_f32 v14, v14, v16
    v_add_f32 v15, v15, v17
    s_waitcnt vmcnt(10)
    v_lshlrev_b32 v16, 16, v84
    v_and_b32 v17, 0xffff0000, v84
    v_add_f32 v8, v8, v16
    v_add_f32 v9, v9, v17
    v_lshlrev_b32 v16, 16, v85
    v_and_b32 v17, 0xffff0000, v85
    v_add_f32 v10, v10, v16
    v_add_f32 v11, v11, v17
    v_lshlrev_b32 v16, 16, v86
    v_and_b32 v17, 0xffff0000, v86
    v_add_f32 v12, v12, v16
    v_add_f32 v13, v13, v17
    v_lshlrev_b32 v16, 16, v87
    v_and_b32 v17, 0xffff0000, v87
    v_add_f32 v14, v14, v16
    v_add_f32 v15, v15, v17
    s_waitcnt vmcnt(9)
    v_lshlrev_b32 v16, 16, v88
    v_and_b32 v17, 0xffff0000, v88
    v_add_f32 v8, v8, v16
    v_add_f32 v9, v9, v17
    v_lshlrev_b32 v16, 16, v89
    v_and_b32 v17, 0xffff0000, v89
    v_add_f32 v10, v10, v16
    v_add_f32 v11, v11, v17
    v_lshlrev_b32 v16, 16, v90
    v_and_b32 v17, 0xffff0000, v90
    v_add_f32 v12, v12, v16
    v_add_f32 v13, v13, v17
    v_lshlrev_b32 v16, 16, v91
    v_and_b32 v17, 0xffff0000, v91
    v_add_f32 v14, v14, v16
    v_add_f32 v15, v15, v17
    s_waitcnt vmcnt(8)
    v_lshlrev_b32 v16, 16, v92
    v_and_b32 v17, 0xffff0000, v92
    v_add_f32 v8, v8, v16
    v_add_f32 v9, v9, v17
    v_lshlrev_b32 v16, 16, v93
    v_and_b32 v17, 0xffff0000, v93
    v_add_f32 v10, v10, v16
    v_add_f32 v11, v11, v17
    v_lshlrev_b32 v16, 16, v94
    v_and_b32 v17, 0xffff0000, v94
    v_add_f32 v12, v12, v16
    v_add_f32 v13, v13, v17
    v_lshlrev_b32 v16, 16, v95
    v_and_b32 v17, 0xffff0000, v95
    v_add_f32 v14, v14, v16
    v_add_f32 v15, v15, v17
    v_cvt_pk_bf16_f32 v24, v8, v9
    v_cvt_pk_bf16_f32 v25, v10, v11
    v_cvt_pk_bf16_f32 v26, v12, v13
    v_cvt_pk_bf16_f32 v27, v14, v15
    s_lshl_b32 s3, s45, 5
    s_add_u32 s3, s3, s47
    buffer_store_dwordx4 v[24:27], v2, s[56:59], s3 offen
    s_waitcnt vmcnt(8)
    v_lshlrev_b32 v8, 16, v96
    v_and_b32 v9, 0xffff0000, v96
    v_lshlrev_b32 v10, 16, v97
    v_and_b32 v11, 0xffff0000, v97
    v_lshlrev_b32 v12, 16, v98
    v_and_b32 v13, 0xffff0000, v98
    v_lshlrev_b32 v14, 16, v99
    v_and_b32 v15, 0xffff0000, v99
    s_waitcnt vmcnt(7)
    v_lshlrev_b32 v16, 16, v100
    v_and_b32 v17, 0xffff0000, v100
    v_add_f32 v8, v8, v16
    v_add_f32 v9, v9, v17
    v_lshlrev_b32 v16, 16, v101
    v_and_b32 v17, 0xffff0000, v101
    v_add_f32 v10, v10, v16
    v_add_f32 v11, v11, v17
    v_lshlrev_b32 v16, 16, v102
    v_and_b32 v17, 0xffff0000, v102
    v_add_f32 v12, v12, v16
    v_add_f32 v13, v13, v17
    v_lshlrev_b32 v16, 16, v103
    v_and_b32 v17, 0xffff0000, v103
    v_add_f32 v14, v14, v16
    v_add_f32 v15, v15, v17
    s_waitcnt vmcnt(6)
    v_lshlrev_b32 v16, 16, v104
    v_and_b32 v17, 0xffff0000, v104
    v_add_f32 v8, v8, v16
    v_add_f32 v9, v9, v17
    v_lshlrev_b32 v16, 16, v105
    v_and_b32 v17, 0xffff0000, v105
    v_add_f32 v10, v10, v16
    v_add_f32 v11, v11, v17
    v_lshlrev_b32 v16, 16, v106
    v_and_b32 v17, 0xffff0000, v106
    v_add_f32 v12, v12, v16
    v_add_f32 v13, v13, v17
    v_lshlrev_b32 v16, 16, v107
    v_and_b32 v17, 0xffff0000, v107
    v_add_f32 v14, v14, v16
    v_add_f32 v15, v15, v17
    s_waitcnt vmcnt(5)
    v_lshlrev_b32 v16, 16, v108
    v_and_b32 v17, 0xffff0000, v108
    v_add_f32 v8, v8, v16
    v_add_f32 v9, v9, v17
    v_lshlrev_b32 v16, 16, v109
    v_and_b32 v17, 0xffff0000, v109
    v_add_f32 v10, v10, v16
    v_add_f32 v11, v11, v17
    v_lshlrev_b32 v16, 16, v110
    v_and_b32 v17, 0xffff0000, v110
    v_add_f32 v12, v12, v16
    v_add_f32 v13, v13, v17
    v_lshlrev_b32 v16, 16, v111
    v_and_b32 v17, 0xffff0000, v111
    v_add_f32 v14, v14, v16
    v_add_f32 v15, v15, v17
    s_waitcnt vmcnt(4)
    v_lshlrev_b32 v16, 16, v112
    v_and_b32 v17, 0xffff0000, v112
    v_add_f32 v8, v8, v16
    v_add_f32 v9, v9, v17
    v_lshlrev_b32 v16, 16, v113
    v_and_b32 v17, 0xffff0000, v113
    v_add_f32 v10, v10, v16
    v_add_f32 v11, v11, v17
    v_lshlrev_b32 v16, 16, v114
    v_and_b32 v17, 0xffff0000, v114
    v_add_f32 v12, v12, v16
    v_add_f32 v13, v13, v17
    v_lshlrev_b32 v16, 16, v115
    v_and_b32 v17, 0xffff0000, v115
    v_add_f32 v14, v14, v16
    v_add_f32 v15, v15, v17
    s_waitcnt vmcnt(3)
    v_lshlrev_b32 v16, 16, v116
    v_and_b32 v17, 0xffff0000, v116
    v_add_f32 v8, v8, v16
    v_add_f32 v9, v9, v17
    v_lshlrev_b32 v16, 16, v117
    v_and_b32 v17, 0xffff0000, v117
    v_add_f32 v10, v10, v16
    v_add_f32 v11, v11, v17
    v_lshlrev_b32 v16, 16, v118
    v_and_b32 v17, 0xffff0000, v118
    v_add_f32 v12, v12, v16
    v_add_f32 v13, v13, v17
    v_lshlrev_b32 v16, 16, v119
    v_and_b32 v17, 0xffff0000, v119
    v_add_f32 v14, v14, v16
    v_add_f32 v15, v15, v17
    s_waitcnt vmcnt(2)
    v_lshlrev_b32 v16, 16, v120
    v_and_b32 v17, 0xffff0000, v120
    v_add_f32 v8, v8, v16
    v_add_f32 v9, v9, v17
    v_lshlrev_b32 v16, 16, v121
    v_and_b32 v17, 0xffff0000, v121
    v_add_f32 v10, v10, v16
    v_add_f32 v11, v11, v17
    v_lshlrev_b32 v16, 16, v122
    v_and_b32 v17, 0xffff0000, v122
    v_add_f32 v12, v12, v16
    v_add_f32 v13, v13, v17
    v_lshlrev_b32 v16, 16, v123
    v_and_b32 v17, 0xffff0000, v123
    v_add_f32 v14, v14, v16
    v_add_f32 v15, v15, v17
    s_waitcnt vmcnt(1)
    v_lshlrev_b32 v16, 16, v124
    v_and_b32 v17, 0xffff0000, v124
    v_add_f32 v8, v8, v16
    v_add_f32 v9, v9, v17
    v_lshlrev_b32 v16, 16, v125
    v_and_b32 v17, 0xffff0000, v125
    v_add_f32 v10, v10, v16
    v_add_f32 v11, v11, v17
    v_lshlrev_b32 v16, 16, v126
    v_and_b32 v17, 0xffff0000, v126
    v_add_f32 v12, v12, v16
    v_add_f32 v13, v13, v17
    v_lshlrev_b32 v16, 16, v127
    v_and_b32 v17, 0xffff0000, v127
    v_add_f32 v14, v14, v16
    v_add_f32 v15, v15, v17
    v_cvt_pk_bf16_f32 v20, v8, v9
    v_cvt_pk_bf16_f32 v21, v10, v11
    v_cvt_pk_bf16_f32 v22, v12, v13
    v_cvt_pk_bf16_f32 v23, v14, v15
    s_lshl_b32 s3, s50, 5
    s_add_u32 s3, s3, s47
    buffer_store_dwordx4 v[20:23], v2, s[56:59], s3 offen
L_red_done:
    s_endpgm
L_compute:
    v_mov_b32 v30, 0x1c04000
    s_waitcnt lgkmcnt(0)
    s_mov_b32 s32, s6
    s_and_b32 s33, s7, 0xffff
    s_mov_b32 s34, 0x1c04080
    s_mov_b32 s35, 0x20000
    s_mov_b32 s60, s58
    s_and_b32 s61, s59, 0xffff
    s_mov_b32 s62, 0x100
    s_mov_b32 s63, 0x20000
    s_or_b32 s50, s2, s39
    s_cmp_eq_u32 s50, 0
    s_cbranch_scc0 L_no_nonce0
    buffer_load_dword v29, v30, s[32:35], 0 offen sc1
L_no_nonce0:
    v_lshrrev_b32 v2, 3, v1
    v_and_b32 v3, 7, v1
    v_lshrrev_b32 v4, 1, v2
    v_and_b32 v5, 1, v4
    v_lshlrev_b32 v5, 2, v5
    v_xor_b32 v5, v3, v5
    v_lshlrev_b32 v5, 4, v5
    s_mul_i32 s3, s37, 384
    s_mul_i32 s4, s39, 196608
    s_add_u32 s3, s3, s4
    s_mov_b32 s5, 12288
    v_mul_lo_u32 v6, v2, s5
    v_add_u32 v6, v6, v5
    v_add_u32 v208, s3, v6
    v_add_u32 v209, 0x18000, v208
    s_lshl_b32 s3, s38, 7
    s_lshl_b32 s4, s39, 5
    s_add_u32 s3, s3, s4
    s_mul_i32 s3, s3, 1280
    s_mov_b32 s5, 1280
    v_mul_lo_u32 v6, v2, s5
    v_add_u32 v6, s3, v6
    v_xor_b32 v5, v3, v4
    v_lshlrev_b32 v7, 4, v5
    v_xor_b32 v5, 4, v5
    v_lshlrev_b32 v5, 4, v5
    v_add_u32 v212, v6, v7
    v_add_u32 v213, v6, v5
    v_add_u32 v213, 0x2800, v213
    v_add_u32 v214, v6, v7
    v_add_u32 v214, 0x5000, v214
    v_add_u32 v215, v6, v5
    v_add_u32 v215, 0x7800, v215
    s_lshl_b32 s54, s39, 11
    s_lshl_b32 s55, s39, 12
    s_mov_b32 s20, s14
    s_and_b32 s21, s15, 0xffff
    s_mov_b32 s22, 0x780000
    s_mov_b32 s23, 0x20000
    s_mov_b32 s16, s8
    s_and_b32 s17, s9, 0xffff
    s_mov_b32 s18, 0xa0000
    s_mov_b32 s19, 0x20000
    s_mov_b32 s24, s10
    s_and_b32 s25, s11, 0xffff
    s_mov_b32 s26, 0x600000
    s_mov_b32 s27, 0x20000
    v_and_b32 v216, 31, v1
    v_mul_u32_u24 v216, 384, v216
    v_lshrrev_b32 v3, 5, v1
    v_lshl_add_u32 v216, v3, 4, v216
    s_lshl_b32 s3, s38, 2
    s_add_u32 s3, s3, s39
    s_lshl_b32 s3, s3, 5
    s_add_u32 s3, s3, s37
    s_mul_i32 s56, s3, 12288
    s_mov_b32 s47, 0
    s_add_u32 m0, s55, 0x6000
    s_nop 0
    buffer_load_dwordx4 v212, s[16:19], s47 offen lds
    s_add_u32 m0, s55, 0x6400
    s_nop 0
    buffer_load_dwordx4 v213, s[16:19], s47 offen lds
    s_add_u32 m0, s55, 0x6800
    s_nop 0
    buffer_load_dwordx4 v214, s[16:19], s47 offen lds
    s_add_u32 m0, s55, 0x6c00
    s_nop 0
    buffer_load_dwordx4 v215, s[16:19], s47 offen lds
    s_cmp_eq_u32 s50, 0
    s_cbranch_scc0 L_no_nonce
    s_waitcnt vmcnt(4)
    v_add_u32 v29, 0x9e3779b9, v29
    v_cmp_eq_u32 vcc, 0, v29
    v_mov_b32 v4, 0x9e3779b9
    s_nop 0
    v_cndmask_b32 v29, v29, v4, vcc
    s_mov_b64 exec, 1
    buffer_store_dword v29, v30, s[32:35], 0 offen sc1
    v_mov_b32 v4, 0
    buffer_store_dword v29, v4, s[60:63], 0 offen sc1
    s_mov_b64 exec, -1
L_no_nonce:
    v_lshrrev_b32 v32, 5, v1
    v_bfe_u32 v33, v1, 4, 1
    v_bfe_u32 v34, v1, 2, 2
    v_and_b32 v35, 1, v1
    v_lshlrev_b32 v35, 1, v35
    v_bfe_u32 v36, v1, 1, 1
    v_or_b32 v35, v35, v36
    v_lshl_add_u32 v35, v33, 2, v35
    v_lshlrev_b32 v35, 3, v35
    v_lshrrev_b32 v36, 1, v34
    v_lshlrev_b32 v36, 6, v36
    v_add_u32 v36, v35, v36
    v_lshl_add_u32 v37, v32, 3, v34
    v_lshlrev_b32 v38, 7, v37
    v_add_u32 v2, v38, v36
    v_xor_b32 v3, 64, v2
    v_add_u32 v4, 0x14000, v2
    v_add_u32 v5, 0x14000, v3
    v_mul_u32_u24 v14, 320, v37
    v_add_u32 v14, v14, v35
    v_add_u32 v15, 0x14000, v14
    v_and_b32 v38, 31, v1
    v_bfe_u32 v39, v1, 1, 3
    v_xor_b32 v39, v39, v32
    v_lshlrev_b32 v39, 4, v39
    s_lshl_b32 s3, s39, 12
    s_add_u32 s3, s3, 20480
    v_lshl_add_u32 v33, v38, 7, v39
    v_add_u32 v6, s3, v33
    v_xor_b32 v7, 32, v6
    v_xor_b32 v8, 64, v6
    v_xor_b32 v9, 96, v6
    v_add_u32 v10, 0x14000, v6
    v_add_u32 v11, 0x14000, v7
    v_add_u32 v12, 0x14000, v8
    v_add_u32 v13, 0x14000, v9
    v_mul_u32_u24 v16, 320, v38
    v_bfe_u32 v17, v1, 2, 2
    v_xor_b32 v17, v17, v32
    v_lshl_add_u32 v16, v17, 4, v16
    s_mul_i32 s3, s39, 10240
    s_add_u32 s3, s3, 122880
    v_add_u32 v16, s3, v16
    v_xor_b32 v17, 32, v16
    v_lshlrev_b32 v31, 4, v1
    s_lshl_b32 s3, s36, 2
    s_add_u32 s3, s3, s38
    s_lshl_b32 s4, s3, 3
    s_add_u32 s4, s4, s40
    s_lshl_b32 s4, s4, 4
    s_add_u32 s4, s4, s39
    s_lshl_b32 s45, s4, 12
    s_add_u32 s45, s45, 0x0
    s_lshl_b32 s3, s3, 2
    s_add_u32 s3, s3, s41
    s_lshl_b32 s4, s3, 3
    s_add_u32 s4, s4, s40
    s_mul_i32 s4, s4, 40960
    s_mul_i32 s5, s39, 10240
    s_add_u32 s4, s4, s5
    s_add_u32 s52, s4, 0x1000000
    s_lshl_b32 s4, s3, 2
    s_add_u32 s4, s4, s39
    s_lshl_b32 s4, s4, 7
    s_lshl_b32 s5, s40, 2
    s_add_u32 s4, s4, s5
    s_add_u32 s43, s4, 0x1c00000
    s_mov_b32 s46, 0xc0000
    s_mov_b32 s47, 128
    s_add_u32 m0, s54, 0xa000
    s_nop 0
    buffer_load_dwordx4 v208, s[20:23], s46 offen lds
    s_add_u32 m0, s54, 0xbf80
    s_nop 0
    buffer_load_dwordx4 v208, s[20:23], s46 offen offset:128 lds
    s_add_u32 m0, s54, 0xdf00
    s_nop 0
    buffer_load_dwordx4 v208, s[20:23], s46 offen offset:256 lds
    s_add_u32 m0, s54, 0xa400
    s_nop 0
    buffer_load_dwordx4 v209, s[20:23], s46 offen lds
    s_add_u32 m0, s54, 0xc380
    s_nop 0
    buffer_load_dwordx4 v209, s[20:23], s46 offen offset:128 lds
    s_add_u32 m0, s54, 0xe300
    s_nop 0
    buffer_load_dwordx4 v209, s[20:23], s46 offen offset:256 lds
    s_add_u32 m0, s55, 0x10000
    s_nop 0
    buffer_load_dwordx4 v212, s[16:19], s47 offen lds
    s_add_u32 m0, s55, 0x10400
    s_nop 0
    buffer_load_dwordx4 v213, s[16:19], s47 offen lds
    s_add_u32 m0, s55, 0x10800
    s_nop 0
    buffer_load_dwordx4 v214, s[16:19], s47 offen lds
    s_add_u32 m0, s55, 0x10c00
    s_nop 0
    buffer_load_dwordx4 v215, s[16:19], s47 offen lds
    buffer_load_dwordx4 v[200:203], v216, s[24:27], s56 offen offset:320
    buffer_load_dwordx4 v[204:207], v216, s[24:27], s56 offen offset:352
    s_waitcnt vmcnt(12)
    s_barrier
    ds_read_b128 v[56:59], v6 offset:4096
    ds_read_b64_tr_b16 v[32:33], v2
    ds_read_b64_tr_b16 v[34:35], v2 offset:512
    ds_read_b64_tr_b16 v[36:37], v3
    ds_read_b64_tr_b16 v[38:39], v3 offset:512
    ds_read_b64_tr_b16 v[40:41], v2 offset:8192
    ds_read_b64_tr_b16 v[42:43], v2 offset:8704
    ds_read_b64_tr_b16 v[44:45], v3 offset:8192
    ds_read_b64_tr_b16 v[46:47], v3 offset:8704
    ds_read_b64_tr_b16 v[48:49], v2 offset:16384
    ds_read_b64_tr_b16 v[50:51], v2 offset:16896
    ds_read_b64_tr_b16 v[52:53], v3 offset:16384
    ds_read_b64_tr_b16 v[54:55], v3 offset:16896
    ds_read_b128 v[60:63], v7 offset:4096
    s_waitcnt lgkmcnt(11)
    v_mfma_f32_32x32x16_bf16 v[64:79], v[32:35], v[56:59], 0
    ds_read_b64_tr_b16 v[32:33], v2 offset:2048
    ds_read_b64_tr_b16 v[34:35], v2 offset:2560
    s_waitcnt lgkmcnt(11)
    v_mfma_f32_32x32x16_bf16 v[80:95], v[36:39], v[56:59], 0
    ds_read_b64_tr_b16 v[36:37], v3 offset:2048
    ds_read_b64_tr_b16 v[38:39], v3 offset:2560
    s_waitcnt lgkmcnt(11)
    v_mfma_f32_32x32x16_bf16 v[96:111], v[40:43], v[56:59], 0
    ds_read_b64_tr_b16 v[40:41], v2 offset:10240
    ds_read_b64_tr_b16 v[42:43], v2 offset:10752
    s_waitcnt lgkmcnt(11)
    v_mfma_f32_32x32x16_bf16 v[112:127], v[44:47], v[56:59], 0
    ds_read_b64_tr_b16 v[44:45], v3 offset:10240
    ds_read_b64_tr_b16 v[46:47], v3 offset:10752
    s_waitcnt lgkmcnt(11)
    v_mfma_f32_32x32x16_bf16 v[128:143], v[48:51], v[56:59], 0
    ds_read_b64_tr_b16 v[48:49], v2 offset:18432
    ds_read_b64_tr_b16 v[50:51], v2 offset:18944
    s_waitcnt lgkmcnt(11)
    v_mfma_f32_32x32x16_bf16 v[144:159], v[52:55], v[56:59], 0
    ds_read_b64_tr_b16 v[52:53], v3 offset:18432
    ds_read_b64_tr_b16 v[54:55], v3 offset:18944
    ds_read_b128 v[56:59], v8 offset:4096
    s_waitcnt lgkmcnt(11)
    v_mfma_f32_32x32x16_bf16 v[64:79], v[32:35], v[60:63], v[64:79]
    ds_read_b64_tr_b16 v[32:33], v2 offset:4096
    ds_read_b64_tr_b16 v[34:35], v2 offset:4608
    s_waitcnt lgkmcnt(11)
    v_mfma_f32_32x32x16_bf16 v[80:95], v[36:39], v[60:63], v[80:95]
    ds_read_b64_tr_b16 v[36:37], v3 offset:4096
    ds_read_b64_tr_b16 v[38:39], v3 offset:4608
    s_waitcnt lgkmcnt(11)
    v_mfma_f32_32x32x16_bf16 v[96:111], v[40:43], v[60:63], v[96:111]
    ds_read_b64_tr_b16 v[40:41], v2 offset:12288
    ds_read_b64_tr_b16 v[42:43], v2 offset:12800
    s_waitcnt lgkmcnt(11)
    v_mfma_f32_32x32x16_bf16 v[112:127], v[44:47], v[60:63], v[112:127]
    ds_read_b64_tr_b16 v[44:45], v3 offset:12288
    ds_read_b64_tr_b16 v[46:47], v3 offset:12800
    s_waitcnt lgkmcnt(11)
    v_mfma_f32_32x32x16_bf16 v[128:143], v[48:51], v[60:63], v[128:143]
    ds_read_b64_tr_b16 v[48:49], v2 offset:20480
    ds_read_b64_tr_b16 v[50:51], v2 offset:20992
    s_waitcnt lgkmcnt(11)
    v_mfma_f32_32x32x16_bf16 v[144:159], v[52:55], v[60:63], v[144:159]
    ds_read_b64_tr_b16 v[52:53], v3 offset:20480
    ds_read_b64_tr_b16 v[54:55], v3 offset:20992
    ds_read_b128 v[60:63], v9 offset:4096
    s_waitcnt lgkmcnt(11)
    v_mfma_f32_32x32x16_bf16 v[64:79], v[32:35], v[56:59], v[64:79]
    ds_read_b64_tr_b16 v[32:33], v2 offset:6144
    ds_read_b64_tr_b16 v[34:35], v2 offset:6656
    s_waitcnt lgkmcnt(11)
    v_mfma_f32_32x32x16_bf16 v[80:95], v[36:39], v[56:59], v[80:95]
    ds_read_b64_tr_b16 v[36:37], v3 offset:6144
    ds_read_b64_tr_b16 v[38:39], v3 offset:6656
    s_waitcnt lgkmcnt(11)
    v_mfma_f32_32x32x16_bf16 v[96:111], v[40:43], v[56:59], v[96:111]
    ds_read_b64_tr_b16 v[40:41], v2 offset:14336
    ds_read_b64_tr_b16 v[42:43], v2 offset:14848
    s_waitcnt lgkmcnt(11)
    v_mfma_f32_32x32x16_bf16 v[112:127], v[44:47], v[56:59], v[112:127]
    ds_read_b64_tr_b16 v[44:45], v3 offset:14336
    ds_read_b64_tr_b16 v[46:47], v3 offset:14848
    s_waitcnt lgkmcnt(11)
    v_mfma_f32_32x32x16_bf16 v[128:143], v[48:51], v[56:59], v[128:143]
    ds_read_b64_tr_b16 v[48:49], v2 offset:22528
    ds_read_b64_tr_b16 v[50:51], v2 offset:23040
    s_waitcnt lgkmcnt(11)
    v_mfma_f32_32x32x16_bf16 v[144:159], v[52:55], v[56:59], v[144:159]
    ds_read_b64_tr_b16 v[52:53], v3 offset:22528
    ds_read_b64_tr_b16 v[54:55], v3 offset:23040
    s_waitcnt lgkmcnt(10)
    v_mfma_f32_32x32x16_bf16 v[64:79], v[32:35], v[60:63], v[64:79]
    s_waitcnt lgkmcnt(8)
    v_mfma_f32_32x32x16_bf16 v[80:95], v[36:39], v[60:63], v[80:95]
    s_waitcnt lgkmcnt(6)
    v_mfma_f32_32x32x16_bf16 v[96:111], v[40:43], v[60:63], v[96:111]
    s_waitcnt lgkmcnt(0)
    s_waitcnt vmcnt(2)
    s_barrier
    ds_read_b128 v[56:59], v6 offset:45056
    ds_read_b64_tr_b16 v[32:33], v2 offset:40960
    ds_read_b64_tr_b16 v[34:35], v2 offset:41472
    ds_read_b64_tr_b16 v[36:37], v3 offset:40960
    ds_read_b64_tr_b16 v[38:39], v3 offset:41472
    v_mfma_f32_32x32x16_bf16 v[112:127], v[44:47], v[60:63], v[112:127]
    ds_read_b64_tr_b16 v[40:41], v2 offset:49152
    ds_read_b64_tr_b16 v[42:43], v2 offset:49664
    v_mfma_f32_32x32x16_bf16 v[128:143], v[48:51], v[60:63], v[128:143]
    ds_read_b64_tr_b16 v[44:45], v3 offset:49152
    ds_read_b64_tr_b16 v[46:47], v3 offset:49664
    v_mfma_f32_32x32x16_bf16 v[144:159], v[52:55], v[60:63], v[144:159]
    ds_read_b64_tr_b16 v[48:49], v2 offset:57344
    ds_read_b64_tr_b16 v[50:51], v2 offset:57856
    ds_read_b64_tr_b16 v[52:53], v3 offset:57344
    ds_read_b64_tr_b16 v[54:55], v3 offset:57856
    ds_read_b128 v[60:63], v7 offset:45056
    s_waitcnt lgkmcnt(11)
    v_mfma_f32_32x32x16_bf16 v[64:79], v[32:35], v[56:59], v[64:79]
    ds_read_b64_tr_b16 v[32:33], v2 offset:43008
    ds_read_b64_tr_b16 v[34:35], v2 offset:43520
    s_waitcnt lgkmcnt(11)
    v_mfma_f32_32x32x16_bf16 v[80:95], v[36:39], v[56:59], v[80:95]
    ds_read_b64_tr_b16 v[36:37], v3 offset:43008
    ds_read_b64_tr_b16 v[38:39], v3 offset:43520
    s_waitcnt lgkmcnt(11)
    v_mfma_f32_32x32x16_bf16 v[96:111], v[40:43], v[56:59], v[96:111]
    ds_read_b64_tr_b16 v[40:41], v2 offset:51200
    ds_read_b64_tr_b16 v[42:43], v2 offset:51712
    s_waitcnt lgkmcnt(11)
    v_mfma_f32_32x32x16_bf16 v[112:127], v[44:47], v[56:59], v[112:127]
    ds_read_b64_tr_b16 v[44:45], v3 offset:51200
    ds_read_b64_tr_b16 v[46:47], v3 offset:51712
    s_waitcnt lgkmcnt(11)
    v_mfma_f32_32x32x16_bf16 v[128:143], v[48:51], v[56:59], v[128:143]
    ds_read_b64_tr_b16 v[48:49], v2 offset:59392
    ds_read_b64_tr_b16 v[50:51], v2 offset:59904
    s_waitcnt lgkmcnt(11)
    v_mfma_f32_32x32x16_bf16 v[144:159], v[52:55], v[56:59], v[144:159]
    ds_read_b64_tr_b16 v[52:53], v3 offset:59392
    ds_read_b64_tr_b16 v[54:55], v3 offset:59904
    ds_read_b128 v[56:59], v8 offset:45056
    s_waitcnt lgkmcnt(11)
    v_mfma_f32_32x32x16_bf16 v[64:79], v[32:35], v[60:63], v[64:79]
    ds_read_b64_tr_b16 v[32:33], v2 offset:45056
    ds_read_b64_tr_b16 v[34:35], v2 offset:45568
    s_waitcnt lgkmcnt(11)
    v_mfma_f32_32x32x16_bf16 v[80:95], v[36:39], v[60:63], v[80:95]
    ds_read_b64_tr_b16 v[36:37], v3 offset:45056
    ds_read_b64_tr_b16 v[38:39], v3 offset:45568
    s_waitcnt lgkmcnt(11)
    v_mfma_f32_32x32x16_bf16 v[96:111], v[40:43], v[60:63], v[96:111]
    ds_read_b64_tr_b16 v[40:41], v2 offset:53248
    ds_read_b64_tr_b16 v[42:43], v2 offset:53760
    s_waitcnt lgkmcnt(11)
    v_mfma_f32_32x32x16_bf16 v[112:127], v[44:47], v[60:63], v[112:127]
    ds_read_b64_tr_b16 v[44:45], v3 offset:53248
    ds_read_b64_tr_b16 v[46:47], v3 offset:53760
    s_waitcnt lgkmcnt(11)
    v_mfma_f32_32x32x16_bf16 v[128:143], v[48:51], v[60:63], v[128:143]
    ds_read_b64_tr_b16 v[48:49], v2 offset:61440
    ds_read_b64_tr_b16 v[50:51], v2 offset:61952
    s_waitcnt lgkmcnt(11)
    v_mfma_f32_32x32x16_bf16 v[144:159], v[52:55], v[60:63], v[144:159]
    ds_read_b64_tr_b16 v[52:53], v3 offset:61440
    ds_read_b64_tr_b16 v[54:55], v3 offset:61952
    ds_read_b128 v[60:63], v9 offset:45056
    s_waitcnt lgkmcnt(11)
    v_mfma_f32_32x32x16_bf16 v[64:79], v[32:35], v[56:59], v[64:79]
    ds_read_b64_tr_b16 v[32:33], v2 offset:47104
    ds_read_b64_tr_b16 v[34:35], v2 offset:47616
    s_waitcnt lgkmcnt(11)
    v_mfma_f32_32x32x16_bf16 v[80:95], v[36:39], v[56:59], v[80:95]
    ds_read_b64_tr_b16 v[36:37], v3 offset:47104
    ds_read_b64_tr_b16 v[38:39], v3 offset:47616
    s_waitcnt lgkmcnt(11)
    v_mfma_f32_32x32x16_bf16 v[96:111], v[40:43], v[56:59], v[96:111]
    ds_read_b64_tr_b16 v[40:41], v2 offset:55296
    ds_read_b64_tr_b16 v[42:43], v2 offset:55808
    s_waitcnt lgkmcnt(11)
    v_mfma_f32_32x32x16_bf16 v[112:127], v[44:47], v[56:59], v[112:127]
    ds_read_b64_tr_b16 v[44:45], v3 offset:55296
    ds_read_b64_tr_b16 v[46:47], v3 offset:55808
    s_waitcnt lgkmcnt(11)
    v_mfma_f32_32x32x16_bf16 v[128:143], v[48:51], v[56:59], v[128:143]
    ds_read_b64_tr_b16 v[48:49], v2 offset:63488
    ds_read_b64_tr_b16 v[50:51], v2 offset:64000
    s_waitcnt lgkmcnt(11)
    v_mfma_f32_32x32x16_bf16 v[144:159], v[52:55], v[56:59], v[144:159]
    ds_read_b64_tr_b16 v[52:53], v3 offset:63488
    ds_read_b64_tr_b16 v[54:55], v3 offset:64000
    s_waitcnt lgkmcnt(10)
    v_mfma_f32_32x32x16_bf16 v[64:79], v[32:35], v[60:63], v[64:79]
    s_waitcnt lgkmcnt(8)
    v_mfma_f32_32x32x16_bf16 v[80:95], v[36:39], v[60:63], v[80:95]
    s_waitcnt lgkmcnt(6)
    v_mfma_f32_32x32x16_bf16 v[96:111], v[40:43], v[60:63], v[96:111]
    s_waitcnt lgkmcnt(0)
    s_barrier
    ds_read_b128 v[56:59], v10 offset:4096
    ds_read_b64_tr_b16 v[32:33], v4
    ds_read_b64_tr_b16 v[34:35], v4 offset:512
    ds_read_b64_tr_b16 v[36:37], v5
    ds_read_b64_tr_b16 v[38:39], v5 offset:512
    v_mfma_f32_32x32x16_bf16 v[112:127], v[44:47], v[60:63], v[112:127]
    ds_read_b64_tr_b16 v[40:41], v4 offset:8192
    ds_read_b64_tr_b16 v[42:43], v4 offset:8704
    v_mfma_f32_32x32x16_bf16 v[128:143], v[48:51], v[60:63], v[128:143]
    ds_read_b64_tr_b16 v[44:45], v5 offset:8192
    ds_read_b64_tr_b16 v[46:47], v5 offset:8704
    v_mfma_f32_32x32x16_bf16 v[144:159], v[52:55], v[60:63], v[144:159]
    ds_read_b64_tr_b16 v[48:49], v4 offset:16384
    ds_read_b64_tr_b16 v[50:51], v4 offset:16896
    ds_read_b64_tr_b16 v[52:53], v5 offset:16384
    ds_read_b64_tr_b16 v[54:55], v5 offset:16896
    ds_read_b128 v[60:63], v11 offset:4096
    s_waitcnt lgkmcnt(11)
    v_mfma_f32_32x32x16_bf16 v[64:79], v[32:35], v[56:59], v[64:79]
    ds_read_b64_tr_b16 v[32:33], v4 offset:2048
    ds_read_b64_tr_b16 v[34:35], v4 offset:2560
    s_waitcnt lgkmcnt(11)
    v_mfma_f32_32x32x16_bf16 v[80:95], v[36:39], v[56:59], v[80:95]
    ds_read_b64_tr_b16 v[36:37], v5 offset:2048
    ds_read_b64_tr_b16 v[38:39], v5 offset:2560
    s_waitcnt lgkmcnt(11)
    v_mfma_f32_32x32x16_bf16 v[96:111], v[40:43], v[56:59], v[96:111]
    ds_read_b64_tr_b16 v[40:41], v4 offset:10240
    ds_read_b64_tr_b16 v[42:43], v4 offset:10752
    s_waitcnt lgkmcnt(11)
    v_mfma_f32_32x32x16_bf16 v[112:127], v[44:47], v[56:59], v[112:127]
    ds_read_b64_tr_b16 v[44:45], v5 offset:10240
    ds_read_b64_tr_b16 v[46:47], v5 offset:10752
    s_waitcnt lgkmcnt(11)
    v_mfma_f32_32x32x16_bf16 v[128:143], v[48:51], v[56:59], v[128:143]
    ds_read_b64_tr_b16 v[48:49], v4 offset:18432
    ds_read_b64_tr_b16 v[50:51], v4 offset:18944
    s_waitcnt lgkmcnt(11)
    v_mfma_f32_32x32x16_bf16 v[144:159], v[52:55], v[56:59], v[144:159]
    ds_read_b64_tr_b16 v[52:53], v5 offset:18432
    ds_read_b64_tr_b16 v[54:55], v5 offset:18944
    ds_read_b128 v[56:59], v12 offset:4096
    s_waitcnt lgkmcnt(11)
    v_mfma_f32_32x32x16_bf16 v[64:79], v[32:35], v[60:63], v[64:79]
    ds_read_b64_tr_b16 v[32:33], v4 offset:4096
    ds_read_b64_tr_b16 v[34:35], v4 offset:4608
    s_waitcnt lgkmcnt(11)
    v_mfma_f32_32x32x16_bf16 v[80:95], v[36:39], v[60:63], v[80:95]
    ds_read_b64_tr_b16 v[36:37], v5 offset:4096
    ds_read_b64_tr_b16 v[38:39], v5 offset:4608
    s_waitcnt lgkmcnt(11)
    v_mfma_f32_32x32x16_bf16 v[96:111], v[40:43], v[60:63], v[96:111]
    ds_read_b64_tr_b16 v[40:41], v4 offset:12288
    ds_read_b64_tr_b16 v[42:43], v4 offset:12800
    s_waitcnt lgkmcnt(11)
    v_mfma_f32_32x32x16_bf16 v[112:127], v[44:47], v[60:63], v[112:127]
    ds_read_b64_tr_b16 v[44:45], v5 offset:12288
    ds_read_b64_tr_b16 v[46:47], v5 offset:12800
    s_waitcnt lgkmcnt(11)
    v_mfma_f32_32x32x16_bf16 v[128:143], v[48:51], v[60:63], v[128:143]
    ds_read_b64_tr_b16 v[48:49], v4 offset:20480
    ds_read_b64_tr_b16 v[50:51], v4 offset:20992
    s_waitcnt lgkmcnt(11)
    v_mfma_f32_32x32x16_bf16 v[144:159], v[52:55], v[60:63], v[144:159]
    ds_read_b64_tr_b16 v[52:53], v5 offset:20480
    ds_read_b64_tr_b16 v[54:55], v5 offset:20992
    ds_read_b128 v[60:63], v13 offset:4096
    s_waitcnt lgkmcnt(11)
    v_mfma_f32_32x32x16_bf16 v[64:79], v[32:35], v[56:59], v[64:79]
    ds_read_b64_tr_b16 v[32:33], v4 offset:6144
    ds_read_b64_tr_b16 v[34:35], v4 offset:6656
    s_waitcnt lgkmcnt(11)
    v_mfma_f32_32x32x16_bf16 v[80:95], v[36:39], v[56:59], v[80:95]
    ds_read_b64_tr_b16 v[36:37], v5 offset:6144
    ds_read_b64_tr_b16 v[38:39], v5 offset:6656
    s_waitcnt lgkmcnt(11)
    v_mfma_f32_32x32x16_bf16 v[96:111], v[40:43], v[56:59], v[96:111]
    ds_read_b64_tr_b16 v[40:41], v4 offset:14336
    ds_read_b64_tr_b16 v[42:43], v4 offset:14848
    s_waitcnt lgkmcnt(11)
    v_mfma_f32_32x32x16_bf16 v[112:127], v[44:47], v[56:59], v[112:127]
    ds_read_b64_tr_b16 v[44:45], v5 offset:14336
    ds_read_b64_tr_b16 v[46:47], v5 offset:14848
    s_waitcnt lgkmcnt(11)
    v_mfma_f32_32x32x16_bf16 v[128:143], v[48:51], v[56:59], v[128:143]
    ds_read_b64_tr_b16 v[48:49], v4 offset:22528
    ds_read_b64_tr_b16 v[50:51], v4 offset:23040
    s_waitcnt lgkmcnt(11)
    v_mfma_f32_32x32x16_bf16 v[144:159], v[52:55], v[56:59], v[144:159]
    ds_read_b64_tr_b16 v[52:53], v5 offset:22528
    ds_read_b64_tr_b16 v[54:55], v5 offset:23040
    s_waitcnt lgkmcnt(10)
    v_mfma_f32_32x32x16_bf16 v[64:79], v[32:35], v[60:63], v[64:79]
    s_waitcnt lgkmcnt(8)
    v_mfma_f32_32x32x16_bf16 v[80:95], v[36:39], v[60:63], v[80:95]
    s_waitcnt lgkmcnt(6)
    v_mfma_f32_32x32x16_bf16 v[96:111], v[40:43], v[60:63], v[96:111]
    s_waitcnt lgkmcnt(0)
    s_barrier
    ds_read_b128 v[56:59], v6 offset:4096
    ds_read_b64_tr_b16 v[32:33], v2
    ds_read_b64_tr_b16 v[34:35], v2 offset:512
    ds_read_b64_tr_b16 v[36:37], v3
    ds_read_b64_tr_b16 v[38:39], v3 offset:512
    v_mfma_f32_32x32x16_bf16 v[112:127], v[44:47], v[60:63], v[112:127]
    ds_read_b64_tr_b16 v[40:41], v2 offset:8192
    ds_read_b64_tr_b16 v[42:43], v2 offset:8704
    v_mfma_f32_32x32x16_bf16 v[128:143], v[48:51], v[60:63], v[128:143]
    ds_read_b64_tr_b16 v[44:45], v3 offset:8192
    ds_read_b64_tr_b16 v[46:47], v3 offset:8704
    v_mfma_f32_32x32x16_bf16 v[144:159], v[52:55], v[60:63], v[144:159]
    ds_read_b64_tr_b16 v[48:49], v2 offset:16384
    ds_read_b64_tr_b16 v[50:51], v2 offset:16896
    ds_read_b64_tr_b16 v[52:53], v3 offset:16384
    ds_read_b64_tr_b16 v[54:55], v3 offset:16896
    ds_read_b128 v[60:63], v7 offset:4096
    s_waitcnt lgkmcnt(11)
    v_mfma_f32_32x32x16_bf16 v[64:79], v[32:35], v[56:59], v[64:79]
    ds_read_b64_tr_b16 v[32:33], v2 offset:2048
    ds_read_b64_tr_b16 v[34:35], v2 offset:2560
    ds_read_b128 v[160:163], v16
    s_waitcnt lgkmcnt(12)
    v_mfma_f32_32x32x16_bf16 v[80:95], v[36:39], v[56:59], v[80:95]
    ds_read_b64_tr_b16 v[36:37], v3 offset:2048
    ds_read_b64_tr_b16 v[38:39], v3 offset:2560
    ds_read_b128 v[164:167], v17
    s_waitcnt lgkmcnt(13)
    v_mfma_f32_32x32x16_bf16 v[96:111], v[40:43], v[56:59], v[96:111]
    ds_read_b64_tr_b16 v[40:41], v2 offset:10240
    ds_read_b64_tr_b16 v[42:43], v2 offset:10752
    ds_read_b128 v[168:171], v16 offset:64
    s_waitcnt lgkmcnt(14)
    v_mfma_f32_32x32x16_bf16 v[112:127], v[44:47], v[56:59], v[112:127]
    ds_read_b64_tr_b16 v[44:45], v3 offset:10240
    ds_read_b64_tr_b16 v[46:47], v3 offset:10752
    ds_read_b128 v[172:175], v17 offset:64
    s_waitcnt lgkmcnt(15)
    v_mfma_f32_32x32x16_bf16 v[128:143], v[48:51], v[56:59], v[128:143]
    ds_read_b64_tr_b16 v[48:49], v2 offset:18432
    ds_read_b64_tr_b16 v[50:51], v2 offset:18944
    ds_read_b128 v[176:179], v16 offset:128
    s_waitcnt lgkmcnt(15)
    v_mfma_f32_32x32x16_bf16 v[144:159], v[52:55], v[56:59], v[144:159]
    ds_read_b64_tr_b16 v[52:53], v3 offset:18432
    ds_read_b64_tr_b16 v[54:55], v3 offset:18944
    ds_read_b128 v[56:59], v8 offset:4096
    s_waitcnt lgkmcnt(15)
    v_mfma_f32_32x32x16_bf16 v[64:79], v[32:35], v[60:63], v[64:79]
    ds_read_b64_tr_b16 v[32:33], v2 offset:4096
    ds_read_b64_tr_b16 v[34:35], v2 offset:4608
    ds_read_b128 v[180:183], v17 offset:128
    s_waitcnt lgkmcnt(15)
    v_mfma_f32_32x32x16_bf16 v[80:95], v[36:39], v[60:63], v[80:95]
    ds_read_b64_tr_b16 v[36:37], v3 offset:4096
    ds_read_b64_tr_b16 v[38:39], v3 offset:4608
    ds_read_b128 v[184:187], v16 offset:192
    s_waitcnt lgkmcnt(15)
    v_mfma_f32_32x32x16_bf16 v[96:111], v[40:43], v[60:63], v[96:111]
    ds_read_b64_tr_b16 v[40:41], v2 offset:12288
    ds_read_b64_tr_b16 v[42:43], v2 offset:12800
    ds_read_b128 v[188:191], v17 offset:192
    s_waitcnt lgkmcnt(15)
    v_mfma_f32_32x32x16_bf16 v[112:127], v[44:47], v[60:63], v[112:127]
    ds_read_b64_tr_b16 v[44:45], v3 offset:12288
    ds_read_b64_tr_b16 v[46:47], v3 offset:12800
    ds_read_b128 v[192:195], v16 offset:256
    s_waitcnt lgkmcnt(15)
    v_mfma_f32_32x32x16_bf16 v[128:143], v[48:51], v[60:63], v[128:143]
    ds_read_b64_tr_b16 v[48:49], v2 offset:20480
    ds_read_b64_tr_b16 v[50:51], v2 offset:20992
    ds_read_b128 v[196:199], v17 offset:256
    s_waitcnt lgkmcnt(15)
    v_mfma_f32_32x32x16_bf16 v[144:159], v[52:55], v[60:63], v[144:159]
    ds_read_b64_tr_b16 v[52:53], v3 offset:20480
    ds_read_b64_tr_b16 v[54:55], v3 offset:20992
    ds_read_b128 v[60:63], v9 offset:4096
    s_waitcnt lgkmcnt(15)
    v_mfma_f32_32x32x16_bf16 v[64:79], v[32:35], v[56:59], v[64:79]
    ds_read_b64_tr_b16 v[32:33], v2 offset:6144
    ds_read_b64_tr_b16 v[34:35], v2 offset:6656
    s_waitcnt lgkmcnt(15)
    v_mfma_f32_32x32x16_bf16 v[80:95], v[36:39], v[56:59], v[80:95]
    ds_read_b64_tr_b16 v[36:37], v3 offset:6144
    ds_read_b64_tr_b16 v[38:39], v3 offset:6656
    s_waitcnt lgkmcnt(14)
    v_mfma_f32_32x32x16_bf16 v[96:111], v[40:43], v[56:59], v[96:111]
    ds_read_b64_tr_b16 v[40:41], v2 offset:14336
    ds_read_b64_tr_b16 v[42:43], v2 offset:14848
    s_waitcnt lgkmcnt(13)
    v_mfma_f32_32x32x16_bf16 v[112:127], v[44:47], v[56:59], v[112:127]
    ds_read_b64_tr_b16 v[44:45], v3 offset:14336
    ds_read_b64_tr_b16 v[46:47], v3 offset:14848
    s_waitcnt lgkmcnt(12)
    v_mfma_f32_32x32x16_bf16 v[128:143], v[48:51], v[56:59], v[128:143]
    ds_read_b64_tr_b16 v[48:49], v2 offset:22528
    ds_read_b64_tr_b16 v[50:51], v2 offset:23040
    s_waitcnt lgkmcnt(11)
    v_mfma_f32_32x32x16_bf16 v[144:159], v[52:55], v[56:59], v[144:159]
    ds_read_b64_tr_b16 v[52:53], v3 offset:22528
    ds_read_b64_tr_b16 v[54:55], v3 offset:23040
    s_waitcnt lgkmcnt(10)
    v_mfma_f32_32x32x16_bf16 v[64:79], v[32:35], v[60:63], v[64:79]
    s_waitcnt lgkmcnt(8)
    v_mfma_f32_32x32x16_bf16 v[80:95], v[36:39], v[60:63], v[80:95]
    s_waitcnt lgkmcnt(6)
    v_mfma_f32_32x32x16_bf16 v[96:111], v[40:43], v[60:63], v[96:111]
    s_waitcnt lgkmcnt(0)
    s_barrier
    ds_read_b128 v[56:59], v6 offset:45056
    ds_read_b64_tr_b16 v[32:33], v2 offset:40960
    ds_read_b64_tr_b16 v[34:35], v2 offset:41472
    ds_read_b64_tr_b16 v[36:37], v3 offset:40960
    ds_read_b64_tr_b16 v[38:39], v3 offset:41472
    v_mfma_f32_32x32x16_bf16 v[112:127], v[44:47], v[60:63], v[112:127]
    ds_read_b64_tr_b16 v[40:41], v2 offset:49152
    ds_read_b64_tr_b16 v[42:43], v2 offset:49664
    v_mfma_f32_32x32x16_bf16 v[128:143], v[48:51], v[60:63], v[128:143]
    ds_read_b64_tr_b16 v[44:45], v3 offset:49152
    ds_read_b64_tr_b16 v[46:47], v3 offset:49664
    v_mfma_f32_32x32x16_bf16 v[144:159], v[52:55], v[60:63], v[144:159]
    ds_read_b64_tr_b16 v[48:49], v2 offset:57344
    ds_read_b64_tr_b16 v[50:51], v2 offset:57856
    ds_read_b64_tr_b16 v[52:53], v3 offset:57344
    ds_read_b64_tr_b16 v[54:55], v3 offset:57856
    ds_read_b128 v[60:63], v7 offset:45056
    s_waitcnt lgkmcnt(11)
    v_mfma_f32_32x32x16_bf16 v[64:79], v[32:35], v[56:59], v[64:79]
    ds_read_b64_tr_b16 v[32:33], v2 offset:43008
    ds_read_b64_tr_b16 v[34:35], v2 offset:43520
    s_waitcnt lgkmcnt(11)
    v_mfma_f32_32x32x16_bf16 v[80:95], v[36:39], v[56:59], v[80:95]
    ds_read_b64_tr_b16 v[36:37], v3 offset:43008
    ds_read_b64_tr_b16 v[38:39], v3 offset:43520
    s_waitcnt lgkmcnt(11)
    v_mfma_f32_32x32x16_bf16 v[96:111], v[40:43], v[56:59], v[96:111]
    ds_read_b64_tr_b16 v[40:41], v2 offset:51200
    ds_read_b64_tr_b16 v[42:43], v2 offset:51712
    s_waitcnt lgkmcnt(11)
    v_mfma_f32_32x32x16_bf16 v[112:127], v[44:47], v[56:59], v[112:127]
    ds_read_b64_tr_b16 v[44:45], v3 offset:51200
    ds_read_b64_tr_b16 v[46:47], v3 offset:51712
    s_waitcnt lgkmcnt(11)
    v_mfma_f32_32x32x16_bf16 v[128:143], v[48:51], v[56:59], v[128:143]
    ds_read_b64_tr_b16 v[48:49], v2 offset:59392
    ds_read_b64_tr_b16 v[50:51], v2 offset:59904
    s_waitcnt lgkmcnt(11)
    v_mfma_f32_32x32x16_bf16 v[144:159], v[52:55], v[56:59], v[144:159]
    ds_read_b64_tr_b16 v[52:53], v3 offset:59392
    ds_read_b64_tr_b16 v[54:55], v3 offset:59904
    ds_read_b128 v[56:59], v8 offset:45056
    s_waitcnt lgkmcnt(11)
    v_mfma_f32_32x32x16_bf16 v[64:79], v[32:35], v[60:63], v[64:79]
    ds_read_b64_tr_b16 v[32:33], v2 offset:45056
    ds_read_b64_tr_b16 v[34:35], v2 offset:45568
    s_waitcnt lgkmcnt(11)
    v_mfma_f32_32x32x16_bf16 v[80:95], v[36:39], v[60:63], v[80:95]
    ds_read_b64_tr_b16 v[36:37], v3 offset:45056
    ds_read_b64_tr_b16 v[38:39], v3 offset:45568
    s_waitcnt lgkmcnt(11)
    v_mfma_f32_32x32x16_bf16 v[96:111], v[40:43], v[60:63], v[96:111]
    ds_read_b64_tr_b16 v[40:41], v2 offset:53248
    ds_read_b64_tr_b16 v[42:43], v2 offset:53760
    s_waitcnt lgkmcnt(11)
    v_mfma_f32_32x32x16_bf16 v[112:127], v[44:47], v[60:63], v[112:127]
    ds_read_b64_tr_b16 v[44:45], v3 offset:53248
    ds_read_b64_tr_b16 v[46:47], v3 offset:53760
    s_waitcnt lgkmcnt(11)
    v_mfma_f32_32x32x16_bf16 v[128:143], v[48:51], v[60:63], v[128:143]
    ds_read_b64_tr_b16 v[48:49], v2 offset:61440
    ds_read_b64_tr_b16 v[50:51], v2 offset:61952
    s_waitcnt lgkmcnt(11)
    v_mfma_f32_32x32x16_bf16 v[144:159], v[52:55], v[60:63], v[144:159]
    ds_read_b64_tr_b16 v[52:53], v3 offset:61440
    ds_read_b64_tr_b16 v[54:55], v3 offset:61952
    ds_read_b128 v[60:63], v9 offset:45056
    s_waitcnt lgkmcnt(11)
    v_mfma_f32_32x32x16_bf16 v[64:79], v[32:35], v[56:59], v[64:79]
    ds_read_b64_tr_b16 v[32:33], v2 offset:47104
    ds_read_b64_tr_b16 v[34:35], v2 offset:47616
    s_waitcnt lgkmcnt(11)
    v_mfma_f32_32x32x16_bf16 v[80:95], v[36:39], v[56:59], v[80:95]
    ds_read_b64_tr_b16 v[36:37], v3 offset:47104
    ds_read_b64_tr_b16 v[38:39], v3 offset:47616
    s_waitcnt lgkmcnt(11)
    v_mfma_f32_32x32x16_bf16 v[96:111], v[40:43], v[56:59], v[96:111]
    ds_read_b64_tr_b16 v[40:41], v2 offset:55296
    ds_read_b64_tr_b16 v[42:43], v2 offset:55808
    s_waitcnt lgkmcnt(11)
    v_mfma_f32_32x32x16_bf16 v[112:127], v[44:47], v[56:59], v[112:127]
    ds_read_b64_tr_b16 v[44:45], v3 offset:55296
    ds_read_b64_tr_b16 v[46:47], v3 offset:55808
    s_waitcnt lgkmcnt(11)
    v_mfma_f32_32x32x16_bf16 v[128:143], v[48:51], v[56:59], v[128:143]
    ds_read_b64_tr_b16 v[48:49], v2 offset:63488
    ds_read_b64_tr_b16 v[50:51], v2 offset:64000
    s_waitcnt lgkmcnt(11)
    v_mfma_f32_32x32x16_bf16 v[144:159], v[52:55], v[56:59], v[144:159]
    ds_read_b64_tr_b16 v[52:53], v3 offset:63488
    ds_read_b64_tr_b16 v[54:55], v3 offset:64000
    s_waitcnt lgkmcnt(10)
    v_mfma_f32_32x32x16_bf16 v[64:79], v[32:35], v[60:63], v[64:79]
    s_waitcnt lgkmcnt(8)
    v_mfma_f32_32x32x16_bf16 v[80:95], v[36:39], v[60:63], v[80:95]
    s_waitcnt lgkmcnt(6)
    v_mfma_f32_32x32x16_bf16 v[96:111], v[40:43], v[60:63], v[96:111]
    s_waitcnt lgkmcnt(0)
    s_barrier
    ds_read_b128 v[56:59], v10 offset:4096
    ds_read_b64_tr_b16 v[32:33], v4
    ds_read_b64_tr_b16 v[34:35], v4 offset:512
    ds_read_b64_tr_b16 v[36:37], v5
    ds_read_b64_tr_b16 v[38:39], v5 offset:512
    v_mfma_f32_32x32x16_bf16 v[112:127], v[44:47], v[60:63], v[112:127]
    ds_read_b64_tr_b16 v[40:41], v4 offset:8192
    ds_read_b64_tr_b16 v[42:43], v4 offset:8704
    v_mfma_f32_32x32x16_bf16 v[128:143], v[48:51], v[60:63], v[128:143]
    ds_read_b64_tr_b16 v[44:45], v5 offset:8192
    ds_read_b64_tr_b16 v[46:47], v5 offset:8704
    v_mfma_f32_32x32x16_bf16 v[144:159], v[52:55], v[60:63], v[144:159]
    ds_read_b64_tr_b16 v[48:49], v4 offset:16384
    ds_read_b64_tr_b16 v[50:51], v4 offset:16896
    ds_read_b64_tr_b16 v[52:53], v5 offset:16384
    ds_read_b64_tr_b16 v[54:55], v5 offset:16896
    ds_read_b128 v[60:63], v11 offset:4096
    s_waitcnt lgkmcnt(11)
    v_mfma_f32_32x32x16_bf16 v[64:79], v[32:35], v[56:59], v[64:79]
    ds_read_b64_tr_b16 v[32:33], v4 offset:2048
    ds_read_b64_tr_b16 v[34:35], v4 offset:2560
    s_waitcnt lgkmcnt(11)
    v_mfma_f32_32x32x16_bf16 v[80:95], v[36:39], v[56:59], v[80:95]
    ds_read_b64_tr_b16 v[36:37], v5 offset:2048
    ds_read_b64_tr_b16 v[38:39], v5 offset:2560
    s_waitcnt lgkmcnt(11)
    v_mfma_f32_32x32x16_bf16 v[96:111], v[40:43], v[56:59], v[96:111]
    ds_read_b64_tr_b16 v[40:41], v4 offset:10240
    ds_read_b64_tr_b16 v[42:43], v4 offset:10752
    s_waitcnt lgkmcnt(11)
    v_mfma_f32_32x32x16_bf16 v[112:127], v[44:47], v[56:59], v[112:127]
    ds_read_b64_tr_b16 v[44:45], v5 offset:10240
    ds_read_b64_tr_b16 v[46:47], v5 offset:10752
    s_waitcnt lgkmcnt(11)
    v_mfma_f32_32x32x16_bf16 v[128:143], v[48:51], v[56:59], v[128:143]
    ds_read_b64_tr_b16 v[48:49], v4 offset:18432
    ds_read_b64_tr_b16 v[50:51], v4 offset:18944
    s_waitcnt lgkmcnt(11)
    v_mfma_f32_32x32x16_bf16 v[144:159], v[52:55], v[56:59], v[144:159]
    ds_read_b64_tr_b16 v[52:53], v5 offset:18432
    ds_read_b64_tr_b16 v[54:55], v5 offset:18944
    ds_read_b128 v[56:59], v12 offset:4096
    s_waitcnt lgkmcnt(11)
    v_mfma_f32_32x32x16_bf16 v[64:79], v[32:35], v[60:63], v[64:79]
    ds_read_b64_tr_b16 v[32:33], v4 offset:4096
    ds_read_b64_tr_b16 v[34:35], v4 offset:4608
    s_waitcnt lgkmcnt(11)
    v_mfma_f32_32x32x16_bf16 v[80:95], v[36:39], v[60:63], v[80:95]
    ds_read_b64_tr_b16 v[36:37], v5 offset:4096
    ds_read_b64_tr_b16 v[38:39], v5 offset:4608
    s_waitcnt lgkmcnt(11)
    v_mfma_f32_32x32x16_bf16 v[96:111], v[40:43], v[60:63], v[96:111]
    ds_read_b64_tr_b16 v[40:41], v4 offset:12288
    ds_read_b64_tr_b16 v[42:43], v4 offset:12800
    s_waitcnt lgkmcnt(11)
    v_mfma_f32_32x32x16_bf16 v[112:127], v[44:47], v[60:63], v[112:127]
    ds_read_b64_tr_b16 v[44:45], v5 offset:12288
    ds_read_b64_tr_b16 v[46:47], v5 offset:12800
    s_waitcnt lgkmcnt(11)
    v_mfma_f32_32x32x16_bf16 v[128:143], v[48:51], v[60:63], v[128:143]
    ds_read_b64_tr_b16 v[48:49], v4 offset:20480
    ds_read_b64_tr_b16 v[50:51], v4 offset:20992
    s_waitcnt lgkmcnt(11)
    v_mfma_f32_32x32x16_bf16 v[144:159], v[52:55], v[60:63], v[144:159]
    ds_read_b64_tr_b16 v[52:53], v5 offset:20480
    ds_read_b64_tr_b16 v[54:55], v5 offset:20992
    ds_read_b128 v[60:63], v13 offset:4096
    s_waitcnt lgkmcnt(11)
    v_mfma_f32_32x32x16_bf16 v[64:79], v[32:35], v[56:59], v[64:79]
    ds_read_b64_tr_b16 v[32:33], v4 offset:6144
    ds_read_b64_tr_b16 v[34:35], v4 offset:6656
    s_waitcnt lgkmcnt(11)
    v_mfma_f32_32x32x16_bf16 v[80:95], v[36:39], v[56:59], v[80:95]
    ds_read_b64_tr_b16 v[36:37], v5 offset:6144
    ds_read_b64_tr_b16 v[38:39], v5 offset:6656
    s_waitcnt lgkmcnt(11)
    v_mfma_f32_32x32x16_bf16 v[96:111], v[40:43], v[56:59], v[96:111]
    ds_read_b64_tr_b16 v[40:41], v4 offset:14336
    ds_read_b64_tr_b16 v[42:43], v4 offset:14848
    s_waitcnt lgkmcnt(11)
    v_mfma_f32_32x32x16_bf16 v[112:127], v[44:47], v[56:59], v[112:127]
    ds_read_b64_tr_b16 v[44:45], v5 offset:14336
    ds_read_b64_tr_b16 v[46:47], v5 offset:14848
    s_waitcnt lgkmcnt(11)
    v_mfma_f32_32x32x16_bf16 v[128:143], v[48:51], v[56:59], v[128:143]
    ds_read_b64_tr_b16 v[48:49], v4 offset:22528
    ds_read_b64_tr_b16 v[50:51], v4 offset:23040
    s_waitcnt lgkmcnt(11)
    v_mfma_f32_32x32x16_bf16 v[144:159], v[52:55], v[56:59], v[144:159]
    ds_read_b64_tr_b16 v[52:53], v5 offset:22528
    ds_read_b64_tr_b16 v[54:55], v5 offset:23040
    s_waitcnt lgkmcnt(10)
    v_mfma_f32_32x32x16_bf16 v[64:79], v[32:35], v[60:63], v[64:79]
    s_waitcnt lgkmcnt(8)
    v_mfma_f32_32x32x16_bf16 v[80:95], v[36:39], v[60:63], v[80:95]
    s_waitcnt lgkmcnt(6)
    v_mfma_f32_32x32x16_bf16 v[96:111], v[40:43], v[60:63], v[96:111]
    s_waitcnt lgkmcnt(0)
    v_mov_b32 v28, 0
    buffer_load_dword v29, v28, s[60:63], 0 offen sc1
    s_barrier
    ds_read_b128 v[56:59], v6 offset:4096
    ds_read_b64_tr_b16 v[32:33], v2
    ds_read_b64_tr_b16 v[34:35], v2 offset:512
    ds_read_b64_tr_b16 v[36:37], v3
    ds_read_b64_tr_b16 v[38:39], v3 offset:512
    v_mfma_f32_32x32x16_bf16 v[112:127], v[44:47], v[60:63], v[112:127]
    ds_read_b64_tr_b16 v[40:41], v2 offset:8192
    ds_read_b64_tr_b16 v[42:43], v2 offset:8704
    v_mfma_f32_32x32x16_bf16 v[128:143], v[48:51], v[60:63], v[128:143]
    ds_read_b64_tr_b16 v[44:45], v3 offset:8192
    ds_read_b64_tr_b16 v[46:47], v3 offset:8704
    v_mfma_f32_32x32x16_bf16 v[144:159], v[52:55], v[60:63], v[144:159]
    ds_read_b64_tr_b16 v[48:49], v2 offset:16384
    ds_read_b64_tr_b16 v[50:51], v2 offset:16896
    ds_read_b64_tr_b16 v[52:53], v3 offset:16384
    ds_read_b64_tr_b16 v[54:55], v3 offset:16896
    ds_read_b128 v[60:63], v7 offset:4096
    s_waitcnt lgkmcnt(11)
    v_mfma_f32_32x32x16_bf16 v[64:79], v[32:35], v[56:59], v[64:79]
    ds_read_b64_tr_b16 v[32:33], v2 offset:2048
    ds_read_b64_tr_b16 v[34:35], v2 offset:2560
    s_waitcnt lgkmcnt(11)
    v_mfma_f32_32x32x16_bf16 v[80:95], v[36:39], v[56:59], v[80:95]
    ds_read_b64_tr_b16 v[36:37], v3 offset:2048
    ds_read_b64_tr_b16 v[38:39], v3 offset:2560
    s_waitcnt lgkmcnt(11)
    v_mfma_f32_32x32x16_bf16 v[96:111], v[40:43], v[56:59], v[96:111]
    ds_read_b64_tr_b16 v[40:41], v2 offset:10240
    ds_read_b64_tr_b16 v[42:43], v2 offset:10752
    s_waitcnt lgkmcnt(11)
    v_mfma_f32_32x32x16_bf16 v[112:127], v[44:47], v[56:59], v[112:127]
    ds_read_b64_tr_b16 v[44:45], v3 offset:10240
    ds_read_b64_tr_b16 v[46:47], v3 offset:10752
    s_waitcnt lgkmcnt(11)
    v_mfma_f32_32x32x16_bf16 v[128:143], v[48:51], v[56:59], v[128:143]
    ds_read_b64_tr_b16 v[48:49], v2 offset:18432
    ds_read_b64_tr_b16 v[50:51], v2 offset:18944
    s_waitcnt lgkmcnt(11)
    v_mfma_f32_32x32x16_bf16 v[144:159], v[52:55], v[56:59], v[144:159]
    ds_read_b64_tr_b16 v[52:53], v3 offset:18432
    ds_read_b64_tr_b16 v[54:55], v3 offset:18944
    ds_read_b128 v[56:59], v8 offset:4096
    s_waitcnt lgkmcnt(11)
    v_mfma_f32_32x32x16_bf16 v[64:79], v[32:35], v[60:63], v[64:79]
    ds_read_b64_tr_b16 v[32:33], v2 offset:4096
    ds_read_b64_tr_b16 v[34:35], v2 offset:4608
    s_waitcnt lgkmcnt(11)
    v_mfma_f32_32x32x16_bf16 v[80:95], v[36:39], v[60:63], v[80:95]
    ds_read_b64_tr_b16 v[36:37], v3 offset:4096
    ds_read_b64_tr_b16 v[38:39], v3 offset:4608
    s_waitcnt lgkmcnt(11)
    v_mfma_f32_32x32x16_bf16 v[96:111], v[40:43], v[60:63], v[96:111]
    ds_read_b64_tr_b16 v[40:41], v2 offset:12288
    ds_read_b64_tr_b16 v[42:43], v2 offset:12800
    s_waitcnt lgkmcnt(11)
    v_mfma_f32_32x32x16_bf16 v[112:127], v[44:47], v[60:63], v[112:127]
    ds_read_b64_tr_b16 v[44:45], v3 offset:12288
    ds_read_b64_tr_b16 v[46:47], v3 offset:12800
    s_waitcnt lgkmcnt(11)
    v_mfma_f32_32x32x16_bf16 v[128:143], v[48:51], v[60:63], v[128:143]
    ds_read_b64_tr_b16 v[48:49], v2 offset:20480
    ds_read_b64_tr_b16 v[50:51], v2 offset:20992
    s_waitcnt lgkmcnt(11)
    v_mfma_f32_32x32x16_bf16 v[144:159], v[52:55], v[60:63], v[144:159]
    ds_read_b64_tr_b16 v[52:53], v3 offset:20480
    ds_read_b64_tr_b16 v[54:55], v3 offset:20992
    ds_read_b128 v[60:63], v9 offset:4096
    s_waitcnt lgkmcnt(11)
    v_mfma_f32_32x32x16_bf16 v[64:79], v[32:35], v[56:59], v[64:79]
    ds_read_b64_tr_b16 v[32:33], v2 offset:6144
    ds_read_b64_tr_b16 v[34:35], v2 offset:6656
    s_waitcnt lgkmcnt(11)
    v_mfma_f32_32x32x16_bf16 v[80:95], v[36:39], v[56:59], v[80:95]
    ds_read_b64_tr_b16 v[36:37], v3 offset:6144
    ds_read_b64_tr_b16 v[38:39], v3 offset:6656
    s_waitcnt lgkmcnt(11)
    v_mfma_f32_32x32x16_bf16 v[96:111], v[40:43], v[56:59], v[96:111]
    ds_read_b64_tr_b16 v[40:41], v2 offset:14336
    ds_read_b64_tr_b16 v[42:43], v2 offset:14848
    s_waitcnt lgkmcnt(11)
    v_mfma_f32_32x32x16_bf16 v[112:127], v[44:47], v[56:59], v[112:127]
    ds_read_b64_tr_b16 v[44:45], v3 offset:14336
    ds_read_b64_tr_b16 v[46:47], v3 offset:14848
    s_waitcnt lgkmcnt(11)
    v_mfma_f32_32x32x16_bf16 v[128:143], v[48:51], v[56:59], v[128:143]
    ds_read_b64_tr_b16 v[48:49], v2 offset:22528
    ds_read_b64_tr_b16 v[50:51], v2 offset:23040
    s_waitcnt lgkmcnt(11)
    v_mfma_f32_32x32x16_bf16 v[144:159], v[52:55], v[56:59], v[144:159]
    ds_read_b64_tr_b16 v[52:53], v3 offset:22528
    ds_read_b64_tr_b16 v[54:55], v3 offset:23040
    s_waitcnt lgkmcnt(10)
    v_mfma_f32_32x32x16_bf16 v[64:79], v[32:35], v[60:63], v[64:79]
    s_waitcnt lgkmcnt(8)
    v_mfma_f32_32x32x16_bf16 v[80:95], v[36:39], v[60:63], v[80:95]
    s_waitcnt lgkmcnt(6)
    v_mfma_f32_32x32x16_bf16 v[96:111], v[40:43], v[60:63], v[96:111]
    s_waitcnt lgkmcnt(0)
    s_barrier
    ds_read_b128 v[56:59], v10 offset:45056
    ds_read_b64_tr_b16 v[32:33], v4 offset:40960
    ds_read_b64_tr_b16 v[34:35], v4 offset:41472
    ds_read_b64_tr_b16 v[36:37], v5 offset:40960
    ds_read_b64_tr_b16 v[38:39], v5 offset:41472
    v_mfma_f32_32x32x16_bf16 v[112:127], v[44:47], v[60:63], v[112:127]
    ds_read_b64_tr_b16 v[40:41], v4 offset:49152
    ds_read_b64_tr_b16 v[42:43], v4 offset:49664
    v_mfma_f32_32x32x16_bf16 v[128:143], v[48:51], v[60:63], v[128:143]
    ds_read_b64_tr_b16 v[44:45], v5 offset:49152
    ds_read_b64_tr_b16 v[46:47], v5 offset:49664
    v_mfma_f32_32x32x16_bf16 v[144:159], v[52:55], v[60:63], v[144:159]
    ds_read_b64_tr_b16 v[48:49], v4 offset:57344
    ds_read_b64_tr_b16 v[50:51], v4 offset:57856
    ds_read_b64_tr_b16 v[52:53], v5 offset:57344
    ds_read_b64_tr_b16 v[54:55], v5 offset:57856
    ds_read_b128 v[60:63], v11 offset:45056
    s_waitcnt lgkmcnt(11)
    v_mfma_f32_32x32x16_bf16 v[64:79], v[32:35], v[56:59], v[64:79]
    ds_read_b64_tr_b16 v[32:33], v4 offset:43008
    ds_read_b64_tr_b16 v[34:35], v4 offset:43520
    s_waitcnt lgkmcnt(11)
    v_mfma_f32_32x32x16_bf16 v[80:95], v[36:39], v[56:59], v[80:95]
    ds_read_b64_tr_b16 v[36:37], v5 offset:43008
    ds_read_b64_tr_b16 v[38:39], v5 offset:43520
    s_waitcnt lgkmcnt(11)
    v_mfma_f32_32x32x16_bf16 v[96:111], v[40:43], v[56:59], v[96:111]
    ds_read_b64_tr_b16 v[40:41], v4 offset:51200
    ds_read_b64_tr_b16 v[42:43], v4 offset:51712
    s_waitcnt lgkmcnt(11)
    v_mfma_f32_32x32x16_bf16 v[112:127], v[44:47], v[56:59], v[112:127]
    ds_read_b64_tr_b16 v[44:45], v5 offset:51200
    ds_read_b64_tr_b16 v[46:47], v5 offset:51712
    s_waitcnt lgkmcnt(11)
    v_mfma_f32_32x32x16_bf16 v[128:143], v[48:51], v[56:59], v[128:143]
    ds_read_b64_tr_b16 v[48:49], v4 offset:59392
    ds_read_b64_tr_b16 v[50:51], v4 offset:59904
    s_waitcnt lgkmcnt(11)
    v_mfma_f32_32x32x16_bf16 v[144:159], v[52:55], v[56:59], v[144:159]
    ds_read_b64_tr_b16 v[52:53], v5 offset:59392
    ds_read_b64_tr_b16 v[54:55], v5 offset:59904
    ds_read_b128 v[56:59], v12 offset:45056
    s_waitcnt lgkmcnt(11)
    v_mfma_f32_32x32x16_bf16 v[64:79], v[32:35], v[60:63], v[64:79]
    ds_read_b64_tr_b16 v[32:33], v4 offset:45056
    ds_read_b64_tr_b16 v[34:35], v4 offset:45568
    s_waitcnt lgkmcnt(11)
    v_mfma_f32_32x32x16_bf16 v[80:95], v[36:39], v[60:63], v[80:95]
    ds_read_b64_tr_b16 v[36:37], v5 offset:45056
    ds_read_b64_tr_b16 v[38:39], v5 offset:45568
    s_waitcnt lgkmcnt(11)
    v_mfma_f32_32x32x16_bf16 v[96:111], v[40:43], v[60:63], v[96:111]
    ds_read_b64_tr_b16 v[40:41], v4 offset:53248
    ds_read_b64_tr_b16 v[42:43], v4 offset:53760
    s_waitcnt lgkmcnt(11)
    v_mfma_f32_32x32x16_bf16 v[112:127], v[44:47], v[60:63], v[112:127]
    ds_read_b64_tr_b16 v[44:45], v5 offset:53248
    ds_read_b64_tr_b16 v[46:47], v5 offset:53760
    s_waitcnt lgkmcnt(11)
    v_mfma_f32_32x32x16_bf16 v[128:143], v[48:51], v[60:63], v[128:143]
    ds_read_b64_tr_b16 v[48:49], v4 offset:61440
    ds_read_b64_tr_b16 v[50:51], v4 offset:61952
    s_waitcnt lgkmcnt(11)
    v_mfma_f32_32x32x16_bf16 v[144:159], v[52:55], v[60:63], v[144:159]
    ds_read_b64_tr_b16 v[52:53], v5 offset:61440
    ds_read_b64_tr_b16 v[54:55], v5 offset:61952
    ds_read_b128 v[60:63], v13 offset:45056
    s_waitcnt lgkmcnt(11)
    v_mfma_f32_32x32x16_bf16 v[64:79], v[32:35], v[56:59], v[64:79]
    ds_read_b64_tr_b16 v[32:33], v4 offset:47104
    ds_read_b64_tr_b16 v[34:35], v4 offset:47616
    s_waitcnt lgkmcnt(11)
    v_mfma_f32_32x32x16_bf16 v[80:95], v[36:39], v[56:59], v[80:95]
    ds_read_b64_tr_b16 v[36:37], v5 offset:47104
    ds_read_b64_tr_b16 v[38:39], v5 offset:47616
    s_waitcnt lgkmcnt(11)
    v_mfma_f32_32x32x16_bf16 v[96:111], v[40:43], v[56:59], v[96:111]
    ds_read_b64_tr_b16 v[40:41], v4 offset:55296
    ds_read_b64_tr_b16 v[42:43], v4 offset:55808
    s_waitcnt lgkmcnt(11)
    v_mfma_f32_32x32x16_bf16 v[112:127], v[44:47], v[56:59], v[112:127]
    ds_read_b64_tr_b16 v[44:45], v5 offset:55296
    ds_read_b64_tr_b16 v[46:47], v5 offset:55808
    s_waitcnt lgkmcnt(11)
    v_mfma_f32_32x32x16_bf16 v[128:143], v[48:51], v[56:59], v[128:143]
    ds_read_b64_tr_b16 v[48:49], v4 offset:63488
    ds_read_b64_tr_b16 v[50:51], v4 offset:64000
    s_waitcnt lgkmcnt(11)
    v_mfma_f32_32x32x16_bf16 v[144:159], v[52:55], v[56:59], v[144:159]
    ds_read_b64_tr_b16 v[52:53], v5 offset:63488
    ds_read_b64_tr_b16 v[54:55], v5 offset:64000
    s_waitcnt lgkmcnt(10)
    v_mfma_f32_32x32x16_bf16 v[64:79], v[32:35], v[60:63], v[64:79]
    s_waitcnt lgkmcnt(8)
    v_mfma_f32_32x32x16_bf16 v[80:95], v[36:39], v[60:63], v[80:95]
    s_waitcnt lgkmcnt(6)
    v_mfma_f32_32x32x16_bf16 v[96:111], v[40:43], v[60:63], v[96:111]
    s_waitcnt lgkmcnt(0)
    s_barrier
    ds_read_b128 v[56:59], v6 offset:45056
    ds_read_b64_tr_b16 v[32:33], v2 offset:40960
    ds_read_b64_tr_b16 v[34:35], v2 offset:41472
    ds_read_b64_tr_b16 v[36:37], v3 offset:40960
    ds_read_b64_tr_b16 v[38:39], v3 offset:41472
    v_mfma_f32_32x32x16_bf16 v[112:127], v[44:47], v[60:63], v[112:127]
    ds_read_b64_tr_b16 v[40:41], v2 offset:49152
    ds_read_b64_tr_b16 v[42:43], v2 offset:49664
    v_mfma_f32_32x32x16_bf16 v[128:143], v[48:51], v[60:63], v[128:143]
    ds_read_b64_tr_b16 v[44:45], v3 offset:49152
    ds_read_b64_tr_b16 v[46:47], v3 offset:49664
    v_mfma_f32_32x32x16_bf16 v[144:159], v[52:55], v[60:63], v[144:159]
    ds_read_b64_tr_b16 v[48:49], v2 offset:57344
    ds_read_b64_tr_b16 v[50:51], v2 offset:57856
    ds_read_b64_tr_b16 v[52:53], v3 offset:57344
    ds_read_b64_tr_b16 v[54:55], v3 offset:57856
    ds_read_b128 v[60:63], v7 offset:45056
    s_waitcnt lgkmcnt(11)
    v_mfma_f32_32x32x16_bf16 v[64:79], v[32:35], v[56:59], v[64:79]
    ds_read_b64_tr_b16 v[32:33], v2 offset:43008
    ds_read_b64_tr_b16 v[34:35], v2 offset:43520
    s_waitcnt lgkmcnt(11)
    v_mfma_f32_32x32x16_bf16 v[80:95], v[36:39], v[56:59], v[80:95]
    ds_read_b64_tr_b16 v[36:37], v3 offset:43008
    ds_read_b64_tr_b16 v[38:39], v3 offset:43520
    s_waitcnt lgkmcnt(11)
    v_mfma_f32_32x32x16_bf16 v[96:111], v[40:43], v[56:59], v[96:111]
    ds_read_b64_tr_b16 v[40:41], v2 offset:51200
    ds_read_b64_tr_b16 v[42:43], v2 offset:51712
    s_waitcnt lgkmcnt(11)
    v_mfma_f32_32x32x16_bf16 v[112:127], v[44:47], v[56:59], v[112:127]
    ds_read_b64_tr_b16 v[44:45], v3 offset:51200
    ds_read_b64_tr_b16 v[46:47], v3 offset:51712
    s_waitcnt lgkmcnt(11)
    v_mfma_f32_32x32x16_bf16 v[128:143], v[48:51], v[56:59], v[128:143]
    ds_read_b64_tr_b16 v[48:49], v2 offset:59392
    ds_read_b64_tr_b16 v[50:51], v2 offset:59904
    s_waitcnt lgkmcnt(11)
    v_mfma_f32_32x32x16_bf16 v[144:159], v[52:55], v[56:59], v[144:159]
    ds_read_b64_tr_b16 v[52:53], v3 offset:59392
    ds_read_b64_tr_b16 v[54:55], v3 offset:59904
    ds_read_b128 v[56:59], v8 offset:45056
    s_waitcnt lgkmcnt(11)
    v_mfma_f32_32x32x16_bf16 v[64:79], v[32:35], v[60:63], v[64:79]
    ds_read_b64_tr_b16 v[32:33], v2 offset:45056
    ds_read_b64_tr_b16 v[34:35], v2 offset:45568
    s_waitcnt lgkmcnt(11)
    v_mfma_f32_32x32x16_bf16 v[80:95], v[36:39], v[60:63], v[80:95]
    ds_read_b64_tr_b16 v[36:37], v3 offset:45056
    ds_read_b64_tr_b16 v[38:39], v3 offset:45568
    s_waitcnt lgkmcnt(11)
    v_mfma_f32_32x32x16_bf16 v[96:111], v[40:43], v[60:63], v[96:111]
    ds_read_b64_tr_b16 v[40:41], v2 offset:53248
    ds_read_b64_tr_b16 v[42:43], v2 offset:53760
    s_waitcnt lgkmcnt(11)
    v_mfma_f32_32x32x16_bf16 v[112:127], v[44:47], v[60:63], v[112:127]
    ds_read_b64_tr_b16 v[44:45], v3 offset:53248
    ds_read_b64_tr_b16 v[46:47], v3 offset:53760
    s_waitcnt lgkmcnt(11)
    v_mfma_f32_32x32x16_bf16 v[128:143], v[48:51], v[60:63], v[128:143]
    ds_read_b64_tr_b16 v[48:49], v2 offset:61440
    ds_read_b64_tr_b16 v[50:51], v2 offset:61952
    s_waitcnt lgkmcnt(11)
    v_mfma_f32_32x32x16_bf16 v[144:159], v[52:55], v[60:63], v[144:159]
    ds_read_b64_tr_b16 v[52:53], v3 offset:61440
    ds_read_b64_tr_b16 v[54:55], v3 offset:61952
    ds_read_b128 v[60:63], v9 offset:45056
    s_waitcnt lgkmcnt(11)
    v_mfma_f32_32x32x16_bf16 v[64:79], v[32:35], v[56:59], v[64:79]
    ds_read_b64_tr_b16 v[32:33], v2 offset:47104
    ds_read_b64_tr_b16 v[34:35], v2 offset:47616
    s_waitcnt lgkmcnt(11)
    v_mfma_f32_32x32x16_bf16 v[80:95], v[36:39], v[56:59], v[80:95]
    ds_read_b64_tr_b16 v[36:37], v3 offset:47104
    ds_read_b64_tr_b16 v[38:39], v3 offset:47616
    s_waitcnt lgkmcnt(11)
    v_mfma_f32_32x32x16_bf16 v[96:111], v[40:43], v[56:59], v[96:111]
    ds_read_b64_tr_b16 v[40:41], v2 offset:55296
    ds_read_b64_tr_b16 v[42:43], v2 offset:55808
    s_waitcnt lgkmcnt(11)
    v_mfma_f32_32x32x16_bf16 v[112:127], v[44:47], v[56:59], v[112:127]
    ds_read_b64_tr_b16 v[44:45], v3 offset:55296
    ds_read_b64_tr_b16 v[46:47], v3 offset:55808
    s_waitcnt lgkmcnt(11)
    v_mfma_f32_32x32x16_bf16 v[128:143], v[48:51], v[56:59], v[128:143]
    ds_read_b64_tr_b16 v[48:49], v2 offset:63488
    ds_read_b64_tr_b16 v[50:51], v2 offset:64000
    s_waitcnt lgkmcnt(11)
    v_mfma_f32_32x32x16_bf16 v[144:159], v[52:55], v[56:59], v[144:159]
    ds_read_b64_tr_b16 v[52:53], v3 offset:63488
    ds_read_b64_tr_b16 v[54:55], v3 offset:64000
    s_waitcnt lgkmcnt(10)
    v_mfma_f32_32x32x16_bf16 v[64:79], v[32:35], v[60:63], v[64:79]
    s_waitcnt lgkmcnt(8)
    v_mfma_f32_32x32x16_bf16 v[80:95], v[36:39], v[60:63], v[80:95]
    s_waitcnt lgkmcnt(6)
    v_mfma_f32_32x32x16_bf16 v[96:111], v[40:43], v[60:63], v[96:111]
    s_waitcnt lgkmcnt(0)
    s_barrier
    ds_read_b128 v[56:59], v10 offset:4096
    ds_read_b64_tr_b16 v[32:33], v4
    ds_read_b64_tr_b16 v[34:35], v4 offset:512
    ds_read_b64_tr_b16 v[36:37], v5
    ds_read_b64_tr_b16 v[38:39], v5 offset:512
    v_mfma_f32_32x32x16_bf16 v[112:127], v[44:47], v[60:63], v[112:127]
    ds_read_b64_tr_b16 v[40:41], v4 offset:8192
    ds_read_b64_tr_b16 v[42:43], v4 offset:8704
    v_mfma_f32_32x32x16_bf16 v[128:143], v[48:51], v[60:63], v[128:143]
    ds_read_b64_tr_b16 v[44:45], v5 offset:8192
    ds_read_b64_tr_b16 v[46:47], v5 offset:8704
    v_mfma_f32_32x32x16_bf16 v[144:159], v[52:55], v[60:63], v[144:159]
    ds_read_b64_tr_b16 v[48:49], v4 offset:16384
    ds_read_b64_tr_b16 v[50:51], v4 offset:16896
    ds_read_b64_tr_b16 v[52:53], v5 offset:16384
    ds_read_b64_tr_b16 v[54:55], v5 offset:16896
    ds_read_b128 v[60:63], v11 offset:4096
    s_waitcnt lgkmcnt(11)
    v_mfma_f32_32x32x16_bf16 v[64:79], v[32:35], v[56:59], v[64:79]
    ds_read_b64_tr_b16 v[32:33], v4 offset:2048
    ds_read_b64_tr_b16 v[34:35], v4 offset:2560
    s_waitcnt lgkmcnt(11)
    v_mfma_f32_32x32x16_bf16 v[80:95], v[36:39], v[56:59], v[80:95]
    ds_read_b64_tr_b16 v[36:37], v5 offset:2048
    ds_read_b64_tr_b16 v[38:39], v5 offset:2560
    s_waitcnt lgkmcnt(11)
    v_mfma_f32_32x32x16_bf16 v[96:111], v[40:43], v[56:59], v[96:111]
    ds_read_b64_tr_b16 v[40:41], v4 offset:10240
    ds_read_b64_tr_b16 v[42:43], v4 offset:10752
    s_waitcnt lgkmcnt(11)
    v_mfma_f32_32x32x16_bf16 v[112:127], v[44:47], v[56:59], v[112:127]
    ds_read_b64_tr_b16 v[44:45], v5 offset:10240
    ds_read_b64_tr_b16 v[46:47], v5 offset:10752
    s_waitcnt lgkmcnt(11)
    v_mfma_f32_32x32x16_bf16 v[128:143], v[48:51], v[56:59], v[128:143]
    ds_read_b64_tr_b16 v[48:49], v4 offset:18432
    ds_read_b64_tr_b16 v[50:51], v4 offset:18944
    s_waitcnt lgkmcnt(11)
    v_mfma_f32_32x32x16_bf16 v[144:159], v[52:55], v[56:59], v[144:159]
    ds_read_b64_tr_b16 v[52:53], v5 offset:18432
    ds_read_b64_tr_b16 v[54:55], v5 offset:18944
    ds_read_b128 v[56:59], v12 offset:4096
    s_waitcnt lgkmcnt(11)
    v_mfma_f32_32x32x16_bf16 v[64:79], v[32:35], v[60:63], v[64:79]
    ds_read_b64_tr_b16 v[32:33], v4 offset:4096
    ds_read_b64_tr_b16 v[34:35], v4 offset:4608
    s_waitcnt lgkmcnt(11)
    v_mfma_f32_32x32x16_bf16 v[80:95], v[36:39], v[60:63], v[80:95]
    ds_read_b64_tr_b16 v[36:37], v5 offset:4096
    ds_read_b64_tr_b16 v[38:39], v5 offset:4608
    s_waitcnt lgkmcnt(11)
    v_mfma_f32_32x32x16_bf16 v[96:111], v[40:43], v[60:63], v[96:111]
    ds_read_b64_tr_b16 v[40:41], v4 offset:12288
    ds_read_b64_tr_b16 v[42:43], v4 offset:12800
    s_waitcnt lgkmcnt(11)
    v_mfma_f32_32x32x16_bf16 v[112:127], v[44:47], v[60:63], v[112:127]
    ds_read_b64_tr_b16 v[44:45], v5 offset:12288
    ds_read_b64_tr_b16 v[46:47], v5 offset:12800
    s_waitcnt lgkmcnt(11)
    v_mfma_f32_32x32x16_bf16 v[128:143], v[48:51], v[60:63], v[128:143]
    ds_read_b64_tr_b16 v[48:49], v4 offset:20480
    ds_read_b64_tr_b16 v[50:51], v4 offset:20992
    s_waitcnt lgkmcnt(11)
    v_mfma_f32_32x32x16_bf16 v[144:159], v[52:55], v[60:63], v[144:159]
    ds_read_b64_tr_b16 v[52:53], v5 offset:20480
    ds_read_b64_tr_b16 v[54:55], v5 offset:20992
    ds_read_b128 v[60:63], v13 offset:4096
    s_waitcnt lgkmcnt(11)
    v_mfma_f32_32x32x16_bf16 v[64:79], v[32:35], v[56:59], v[64:79]
    ds_read_b64_tr_b16 v[32:33], v4 offset:6144
    ds_read_b64_tr_b16 v[34:35], v4 offset:6656
    s_waitcnt lgkmcnt(11)
    v_mfma_f32_32x32x16_bf16 v[80:95], v[36:39], v[56:59], v[80:95]
    ds_read_b64_tr_b16 v[36:37], v5 offset:6144
    ds_read_b64_tr_b16 v[38:39], v5 offset:6656
    s_waitcnt lgkmcnt(11)
    v_mfma_f32_32x32x16_bf16 v[96:111], v[40:43], v[56:59], v[96:111]
    ds_read_b64_tr_b16 v[40:41], v4 offset:14336
    ds_read_b64_tr_b16 v[42:43], v4 offset:14848
    s_waitcnt lgkmcnt(11)
    v_mfma_f32_32x32x16_bf16 v[112:127], v[44:47], v[56:59], v[112:127]
    ds_read_b64_tr_b16 v[44:45], v5 offset:14336
    ds_read_b64_tr_b16 v[46:47], v5 offset:14848
    s_waitcnt lgkmcnt(11)
    v_mfma_f32_32x32x16_bf16 v[128:143], v[48:51], v[56:59], v[128:143]
    ds_read_b64_tr_b16 v[48:49], v4 offset:22528
    ds_read_b64_tr_b16 v[50:51], v4 offset:23040
    s_waitcnt lgkmcnt(11)
    v_mfma_f32_32x32x16_bf16 v[144:159], v[52:55], v[56:59], v[144:159]
    ds_read_b64_tr_b16 v[52:53], v5 offset:22528
    ds_read_b64_tr_b16 v[54:55], v5 offset:23040
    s_waitcnt lgkmcnt(10)
    v_mfma_f32_32x32x16_bf16 v[64:79], v[32:35], v[60:63], v[64:79]
    s_waitcnt lgkmcnt(8)
    v_mfma_f32_32x32x16_bf16 v[80:95], v[36:39], v[60:63], v[80:95]
    s_waitcnt lgkmcnt(6)
    v_mfma_f32_32x32x16_bf16 v[96:111], v[40:43], v[60:63], v[96:111]
    s_waitcnt lgkmcnt(0)
    s_barrier
    ds_read_b128 v[16:19], v6
    ds_read_b64_tr_b16 v[32:33], v14
    ds_read_b64_tr_b16 v[34:35], v14 offset:1280
    ds_read_b64_tr_b16 v[36:37], v14 offset:64
    ds_read_b64_tr_b16 v[38:39], v14 offset:1344
    ds_read_b64_tr_b16 v[40:41], v14 offset:128
    ds_read_b64_tr_b16 v[42:43], v14 offset:1408
    v_mfma_f32_32x32x16_bf16 v[112:127], v[44:47], v[60:63], v[112:127]
    ds_read_b64_tr_b16 v[44:45], v14 offset:192
    ds_read_b64_tr_b16 v[46:47], v14 offset:1472
    v_cvt_pk_bf16_f32 v64, v64, v65
    v_cvt_pk_bf16_f32 v65, v66, v67
    v_cvt_pk_bf16_f32 v66, v68, v69
    v_cvt_pk_bf16_f32 v67, v70, v71
    v_cvt_pk_bf16_f32 v68, v72, v73
    v_cvt_pk_bf16_f32 v69, v74, v75
    v_cvt_pk_bf16_f32 v70, v76, v77
    v_cvt_pk_bf16_f32 v71, v78, v79
    v_mfma_f32_32x32x16_bf16 v[128:143], v[48:51], v[60:63], v[128:143]
    ds_read_b64_tr_b16 v[48:49], v14 offset:256
    ds_read_b64_tr_b16 v[50:51], v14 offset:1536
    v_cvt_pk_bf16_f32 v72, v80, v81
    v_cvt_pk_bf16_f32 v73, v82, v83
    v_cvt_pk_bf16_f32 v74, v84, v85
    v_cvt_pk_bf16_f32 v75, v86, v87
    v_cvt_pk_bf16_f32 v76, v88, v89
    v_cvt_pk_bf16_f32 v77, v90, v91
    v_cvt_pk_bf16_f32 v78, v92, v93
    v_cvt_pk_bf16_f32 v79, v94, v95
    v_mfma_f32_32x32x16_bf16 v[144:159], v[52:55], v[60:63], v[144:159]
    v_cvt_pk_bf16_f32 v80, v96, v97
    v_cvt_pk_bf16_f32 v81, v98, v99
    v_cvt_pk_bf16_f32 v82, v100, v101
    v_cvt_pk_bf16_f32 v83, v102, v103
    v_cvt_pk_bf16_f32 v84, v104, v105
    v_cvt_pk_bf16_f32 v85, v106, v107
    v_cvt_pk_bf16_f32 v86, v108, v109
    v_cvt_pk_bf16_f32 v87, v110, v111
    s_waitcnt vmcnt(1)
    v_mfma_f32_32x32x16_bf16 v[240:255], v[160:163], v[64:67], 0
    v_mfma_f32_32x32x16_bf16 v[240:255], v[164:167], v[68:71], v[240:255]
    v_cvt_pk_bf16_f32 v88, v112, v113
    v_cvt_pk_bf16_f32 v89, v114, v115
    v_cvt_pk_bf16_f32 v90, v116, v117
    v_cvt_pk_bf16_f32 v91, v118, v119
    v_cvt_pk_bf16_f32 v92, v120, v121
    v_cvt_pk_bf16_f32 v93, v122, v123
    v_cvt_pk_bf16_f32 v94, v124, v125
    v_cvt_pk_bf16_f32 v95, v126, v127
    v_mfma_f32_32x32x16_bf16 v[240:255], v[168:171], v[72:75], v[240:255]
    v_mfma_f32_32x32x16_bf16 v[240:255], v[172:175], v[76:79], v[240:255]
    v_cvt_pk_bf16_f32 v96, v128, v129
    v_cvt_pk_bf16_f32 v97, v130, v131
    v_cvt_pk_bf16_f32 v98, v132, v133
    v_cvt_pk_bf16_f32 v99, v134, v135
    v_cvt_pk_bf16_f32 v100, v136, v137
    v_cvt_pk_bf16_f32 v101, v138, v139
    v_cvt_pk_bf16_f32 v102, v140, v141
    v_cvt_pk_bf16_f32 v103, v142, v143
    v_mfma_f32_32x32x16_bf16 v[240:255], v[176:179], v[80:83], v[240:255]
    v_mfma_f32_32x32x16_bf16 v[240:255], v[180:183], v[84:87], v[240:255]
    v_cvt_pk_bf16_f32 v104, v144, v145
    v_cvt_pk_bf16_f32 v105, v146, v147
    v_cvt_pk_bf16_f32 v106, v148, v149
    v_cvt_pk_bf16_f32 v107, v150, v151
    v_cvt_pk_bf16_f32 v108, v152, v153
    v_cvt_pk_bf16_f32 v109, v154, v155
    v_cvt_pk_bf16_f32 v110, v156, v157
    v_cvt_pk_bf16_f32 v111, v158, v159
    v_mfma_f32_32x32x16_bf16 v[240:255], v[184:187], v[88:91], v[240:255]
    v_mfma_f32_32x32x16_bf16 v[240:255], v[188:191], v[92:95], v[240:255]
    v_mfma_f32_32x32x16_bf16 v[240:255], v[192:195], v[96:99], v[240:255]
    v_mfma_f32_32x32x16_bf16 v[240:255], v[196:199], v[100:103], v[240:255]
    v_mfma_f32_32x32x16_bf16 v[240:255], v[200:203], v[104:107], v[240:255]
    v_mfma_f32_32x32x16_bf16 v[240:255], v[204:207], v[108:111], v[240:255]
    ds_read_b128 v[20:23], v7
    s_waitcnt lgkmcnt(9)
    v_mfma_f32_32x32x16_bf16 v[112:127], v[16:19], v[32:35], 0
    s_mov_b32 s46, 0x3dd53b95
    s_nop 7
    v_max3_f32 v52, v240, v241, v242
    v_max3_f32 v52, v52, v243, v244
    v_max3_f32 v52, v52, v245, v246
    ds_read_b64_tr_b16 v[32:33], v14 offset:5120
    ds_read_b64_tr_b16 v[34:35], v14 offset:6400
    s_waitcnt lgkmcnt(9)
    v_mfma_f32_32x32x16_bf16 v[128:143], v[16:19], v[36:39], 0
    v_max3_f32 v52, v52, v247, v248
    v_max3_f32 v52, v52, v249, v250
    v_max3_f32 v52, v52, v251, v252
    v_max3_f32 v52, v52, v253, v254
    ds_read_b64_tr_b16 v[36:37], v14 offset:5184
    ds_read_b64_tr_b16 v[38:39], v14 offset:6464
    s_waitcnt lgkmcnt(9)
    v_mfma_f32_32x32x16_bf16 v[144:159], v[16:19], v[40:43], 0
    v_max_f32 v52, v52, v255
    v_mov_b32 v53, v52
    s_nop 1
    v_permlane32_swap_b32 v52, v53
    v_max_f32 v52, v52, v53
    ds_read_b64_tr_b16 v[40:41], v14 offset:5248
    ds_read_b64_tr_b16 v[42:43], v14 offset:6528
    s_waitcnt lgkmcnt(9)
    v_mfma_f32_32x32x16_bf16 v[208:223], v[16:19], v[44:47], 0
    v_mul_f32 v52, s46, v52
    v_fma_f32 v240, v240, s46, -v52
    v_fma_f32 v241, v241, s46, -v52
    v_fma_f32 v242, v242, s46, -v52
    ds_read_b64_tr_b16 v[44:45], v14 offset:5312
    ds_read_b64_tr_b16 v[46:47], v14 offset:6592
    s_waitcnt lgkmcnt(9)
    v_mfma_f32_32x32x16_bf16 v[224:239], v[16:19], v[48:51], 0
    v_fma_f32 v243, v243, s46, -v52
    v_fma_f32 v244, v244, s46, -v52
    v_fma_f32 v245, v245, s46, -v52
    v_fma_f32 v246, v246, s46, -v52
    ds_read_b64_tr_b16 v[48:49], v14 offset:5376
    ds_read_b64_tr_b16 v[50:51], v14 offset:6656
    ds_read_b128 v[16:19], v8
    s_waitcnt lgkmcnt(9)
    v_mfma_f32_32x32x16_bf16 v[112:127], v[20:23], v[32:35], v[112:127]
    v_fma_f32 v247, v247, s46, -v52
    v_fma_f32 v248, v248, s46, -v52
    v_fma_f32 v249, v249, s46, -v52
    v_fma_f32 v250, v250, s46, -v52
    ds_read_b64_tr_b16 v[32:33], v14 offset:10240
    ds_read_b64_tr_b16 v[34:35], v14 offset:11520
    s_waitcnt lgkmcnt(9)
    v_mfma_f32_32x32x16_bf16 v[128:143], v[20:23], v[36:39], v[128:143]
    v_fma_f32 v251, v251, s46, -v52
    v_fma_f32 v252, v252, s46, -v52
    v_fma_f32 v253, v253, s46, -v52
    v_fma_f32 v254, v254, s46, -v52
    ds_read_b64_tr_b16 v[36:37], v14 offset:10304
    ds_read_b64_tr_b16 v[38:39], v14 offset:11584
    s_waitcnt lgkmcnt(9)
    v_mfma_f32_32x32x16_bf16 v[144:159], v[20:23], v[40:43], v[144:159]
    v_fma_f32 v255, v255, s46, -v52
    v_exp_f32 v240, v240
    v_exp_f32 v241, v241
    v_exp_f32 v242, v242
    ds_read_b64_tr_b16 v[40:41], v14 offset:10368
    ds_read_b64_tr_b16 v[42:43], v14 offset:11648
    s_waitcnt lgkmcnt(9)
    v_mfma_f32_32x32x16_bf16 v[208:223], v[20:23], v[44:47], v[208:223]
    v_exp_f32 v243, v243
    v_exp_f32 v244, v244
    v_exp_f32 v245, v245
    v_exp_f32 v246, v246
    ds_read_b64_tr_b16 v[44:45], v14 offset:10432
    ds_read_b64_tr_b16 v[46:47], v14 offset:11712
    s_waitcnt lgkmcnt(9)
    v_mfma_f32_32x32x16_bf16 v[224:239], v[20:23], v[48:51], v[224:239]
    v_exp_f32 v247, v247
    v_exp_f32 v248, v248
    v_exp_f32 v249, v249
    v_exp_f32 v250, v250
    ds_read_b64_tr_b16 v[48:49], v14 offset:10496
    ds_read_b64_tr_b16 v[50:51], v14 offset:11776
    ds_read_b128 v[20:23], v9
    s_waitcnt lgkmcnt(9)
    v_mfma_f32_32x32x16_bf16 v[112:127], v[16:19], v[32:35], v[112:127]
    v_exp_f32 v251, v251
    v_exp_f32 v252, v252
    v_exp_f32 v253, v253
    v_exp_f32 v254, v254
    ds_read_b64_tr_b16 v[32:33], v14 offset:15360
    ds_read_b64_tr_b16 v[34:35], v14 offset:16640
    s_waitcnt lgkmcnt(9)
    v_mfma_f32_32x32x16_bf16 v[128:143], v[16:19], v[36:39], v[128:143]
    v_exp_f32 v255, v255
    v_add_f32 v54, v240, v241
    v_add_f32 v55, v242, v243
    v_add_f32 v54, v54, v244
    ds_read_b64_tr_b16 v[36:37], v14 offset:15424
    ds_read_b64_tr_b16 v[38:39], v14 offset:16704
    s_waitcnt lgkmcnt(9)
    v_mfma_f32_32x32x16_bf16 v[144:159], v[16:19], v[40:43], v[144:159]
    v_add_f32 v55, v55, v245
    v_add_f32 v54, v54, v246
    v_add_f32 v55, v55, v247
    v_add_f32 v54, v54, v248
    ds_read_b64_tr_b16 v[40:41], v14 offset:15488
    ds_read_b64_tr_b16 v[42:43], v14 offset:16768
    s_waitcnt lgkmcnt(9)
    v_mfma_f32_32x32x16_bf16 v[208:223], v[16:19], v[44:47], v[208:223]
    v_add_f32 v55, v55, v249
    v_add_f32 v54, v54, v250
    v_add_f32 v55, v55, v251
    v_add_f32 v54, v54, v252
    ds_read_b64_tr_b16 v[44:45], v14 offset:15552
    ds_read_b64_tr_b16 v[46:47], v14 offset:16832
    s_waitcnt lgkmcnt(9)
    v_mfma_f32_32x32x16_bf16 v[224:239], v[16:19], v[48:51], v[224:239]
    v_add_f32 v55, v55, v253
    v_add_f32 v54, v54, v254
    v_add_f32 v55, v55, v255
    v_add_f32 v54, v54, v55
    ds_read_b64_tr_b16 v[48:49], v14 offset:15616
    ds_read_b64_tr_b16 v[50:51], v14 offset:16896
    s_waitcnt lgkmcnt(8)
    v_mfma_f32_32x32x16_bf16 v[112:127], v[20:23], v[32:35], v[112:127]
    v_mov_b32 v55, v54
    s_nop 1
    v_permlane32_swap_b32 v54, v55
    v_add_f32 v54, v54, v55
    v_rcp_f32 v54, v54
    s_waitcnt lgkmcnt(6)
    v_mfma_f32_32x32x16_bf16 v[128:143], v[20:23], v[36:39], v[128:143]
    v_mul_f32 v240, v240, v54
    v_mul_f32 v241, v241, v54
    v_mul_f32 v242, v242, v54
    v_mul_f32 v243, v243, v54
    s_waitcnt lgkmcnt(0)
    s_barrier
    ds_read_b128 v[16:19], v10 offset:40960
    ds_read_b64_tr_b16 v[32:33], v15 offset:40960
    ds_read_b64_tr_b16 v[34:35], v15 offset:42240
    ds_read_b64_tr_b16 v[36:37], v15 offset:41024
    ds_read_b64_tr_b16 v[38:39], v15 offset:42304
    v_mfma_f32_32x32x16_bf16 v[144:159], v[20:23], v[40:43], v[144:159]
    v_mul_f32 v244, v244, v54
    v_mul_f32 v245, v245, v54
    v_mul_f32 v246, v246, v54
    v_mul_f32 v247, v247, v54
    ds_read_b64_tr_b16 v[40:41], v15 offset:41088
    ds_read_b64_tr_b16 v[42:43], v15 offset:42368
    v_mfma_f32_32x32x16_bf16 v[208:223], v[20:23], v[44:47], v[208:223]
    v_mul_f32 v248, v248, v54
    v_mul_f32 v249, v249, v54
    v_mul_f32 v250, v250, v54
    v_mul_f32 v251, v251, v54
    ds_read_b64_tr_b16 v[44:45], v15 offset:41152
    ds_read_b64_tr_b16 v[46:47], v15 offset:42432
    v_mfma_f32_32x32x16_bf16 v[224:239], v[20:23], v[48:51], v[224:239]
    v_mul_f32 v252, v252, v54
    v_mul_f32 v253, v253, v54
    v_mul_f32 v254, v254, v54
    v_mul_f32 v255, v255, v54
    ds_read_b64_tr_b16 v[48:49], v15 offset:41216
    ds_read_b64_tr_b16 v[50:51], v15 offset:42496
    ds_read_b128 v[20:23], v11 offset:40960
    s_waitcnt lgkmcnt(9)
    v_mfma_f32_32x32x16_bf16 v[112:127], v[16:19], v[32:35], v[112:127]
    v_cvt_pk_bf16_f32 v56, v240, v241
    v_cvt_pk_bf16_f32 v57, v242, v243
    v_cvt_pk_bf16_f32 v58, v244, v245
    v_cvt_pk_bf16_f32 v59, v246, v247
    ds_read_b64_tr_b16 v[32:33], v15 offset:46080
    ds_read_b64_tr_b16 v[34:35], v15 offset:47360
    s_waitcnt lgkmcnt(9)
    v_mfma_f32_32x32x16_bf16 v[128:143], v[16:19], v[36:39], v[128:143]
    v_cvt_pk_bf16_f32 v60, v248, v249
    v_cvt_pk_bf16_f32 v61, v250, v251
    v_cvt_pk_bf16_f32 v62, v252, v253
    v_cvt_pk_bf16_f32 v63, v254, v255
    ds_read_b64_tr_b16 v[36:37], v15 offset:46144
    ds_read_b64_tr_b16 v[38:39], v15 offset:47424
    s_waitcnt lgkmcnt(9)
    v_mfma_f32_32x32x16_bf16 v[144:159], v[16:19], v[40:43], v[144:159]
    ds_read_b64_tr_b16 v[40:41], v15 offset:46208
    ds_read_b64_tr_b16 v[42:43], v15 offset:47488
    s_waitcnt lgkmcnt(9)
    v_mfma_f32_32x32x16_bf16 v[208:223], v[16:19], v[44:47], v[208:223]
    ds_read_b64_tr_b16 v[44:45], v15 offset:46272
    ds_read_b64_tr_b16 v[46:47], v15 offset:47552
    s_waitcnt lgkmcnt(9)
    v_mfma_f32_32x32x16_bf16 v[224:239], v[16:19], v[48:51], v[224:239]
    ds_read_b64_tr_b16 v[48:49], v15 offset:46336
    ds_read_b64_tr_b16 v[50:51], v15 offset:47616
    ds_read_b128 v[16:19], v12 offset:40960
    s_waitcnt lgkmcnt(9)
    v_mfma_f32_32x32x16_bf16 v[112:127], v[20:23], v[32:35], v[112:127]
    ds_read_b64_tr_b16 v[32:33], v15 offset:51200
    ds_read_b64_tr_b16 v[34:35], v15 offset:52480
    s_waitcnt lgkmcnt(9)
    v_mfma_f32_32x32x16_bf16 v[128:143], v[20:23], v[36:39], v[128:143]
    ds_read_b64_tr_b16 v[36:37], v15 offset:51264
    ds_read_b64_tr_b16 v[38:39], v15 offset:52544
    s_waitcnt lgkmcnt(9)
    v_mfma_f32_32x32x16_bf16 v[144:159], v[20:23], v[40:43], v[144:159]
    ds_read_b64_tr_b16 v[40:41], v15 offset:51328
    ds_read_b64_tr_b16 v[42:43], v15 offset:52608
    s_waitcnt lgkmcnt(9)
    v_mfma_f32_32x32x16_bf16 v[208:223], v[20:23], v[44:47], v[208:223]
    ds_read_b64_tr_b16 v[44:45], v15 offset:51392
    ds_read_b64_tr_b16 v[46:47], v15 offset:52672
    s_waitcnt lgkmcnt(9)
    v_mfma_f32_32x32x16_bf16 v[224:239], v[20:23], v[48:51], v[224:239]
    ds_read_b64_tr_b16 v[48:49], v15 offset:51456
    ds_read_b64_tr_b16 v[50:51], v15 offset:52736
    s_waitcnt vmcnt(0)
    v_readfirstlane_b32 s47, v29
    s_nop 3
    s_cmp_lg_u32 s47, 0
    s_cbranch_scc1 L_have_nonce
    s_mov_b32 s51, 0
nonce_cp:
    v_mov_b32 v29, 0
    buffer_load_dword v29, v29, s[60:63], 0 offen sc1
    s_waitcnt vmcnt(0)
    v_readfirstlane_b32 s47, v29
    s_add_u32 s51, s51, 1
    s_cmp_gt_u32 s51, 200000
    s_cbranch_scc1 nonce_cp_done
    s_nop 0
    s_cmp_eq_u32 s47, 0
    s_cbranch_scc1 nonce_cp
nonce_cp_done:
L_have_nonce:
    v_mov_b32 v24, v56
    v_mov_b32 v25, s47
    v_mov_b32 v26, v57
    v_mov_b32 v27, s47
    v_mov_b32 v200, v58
    v_mov_b32 v201, s47
    v_mov_b32 v202, v59
    v_mov_b32 v203, s47
    v_mov_b32 v204, v60
    v_mov_b32 v205, s47
    v_mov_b32 v206, v61
    v_mov_b32 v207, s47
    v_mov_b32 v52, v62
    v_mov_b32 v53, s47
    v_mov_b32 v54, v63
    v_mov_b32 v55, s47
    s_lshl_b32 s3, s41, 14
    s_add_u32 s3, s3, s45
    buffer_store_dwordx4 v[24:27], v31, s[32:35], s3 offen sc1
    buffer_store_dwordx4 v[200:203], v31, s[32:35], s3 offen offset:1024 sc1
    buffer_store_dwordx4 v[204:207], v31, s[32:35], s3 offen offset:2048 sc1
    buffer_store_dwordx4 v[52:55], v31, s[32:35], s3 offen offset:3072 sc1
    ds_read_b128 v[20:23], v13 offset:40960
    s_waitcnt lgkmcnt(9)
    v_mfma_f32_32x32x16_bf16 v[112:127], v[16:19], v[32:35], v[112:127]
    ds_read_b64_tr_b16 v[32:33], v15 offset:56320
    ds_read_b64_tr_b16 v[34:35], v15 offset:57600
    s_waitcnt lgkmcnt(9)
    v_mfma_f32_32x32x16_bf16 v[128:143], v[16:19], v[36:39], v[128:143]
    ds_read_b64_tr_b16 v[36:37], v15 offset:56384
    ds_read_b64_tr_b16 v[38:39], v15 offset:57664
    s_waitcnt lgkmcnt(9)
    v_mfma_f32_32x32x16_bf16 v[144:159], v[16:19], v[40:43], v[144:159]
    ds_read_b64_tr_b16 v[40:41], v15 offset:56448
    ds_read_b64_tr_b16 v[42:43], v15 offset:57728
    s_waitcnt lgkmcnt(9)
    v_mfma_f32_32x32x16_bf16 v[208:223], v[16:19], v[44:47], v[208:223]
    ds_read_b64_tr_b16 v[44:45], v15 offset:56512
    ds_read_b64_tr_b16 v[46:47], v15 offset:57792
    s_waitcnt lgkmcnt(9)
    v_mfma_f32_32x32x16_bf16 v[224:239], v[16:19], v[48:51], v[224:239]
    ds_read_b64_tr_b16 v[48:49], v15 offset:56576
    ds_read_b64_tr_b16 v[50:51], v15 offset:57856
    s_waitcnt lgkmcnt(8)
    v_mfma_f32_32x32x16_bf16 v[112:127], v[20:23], v[32:35], v[112:127]
    s_waitcnt lgkmcnt(6)
    v_mfma_f32_32x32x16_bf16 v[128:143], v[20:23], v[36:39], v[128:143]
    s_waitcnt lgkmcnt(0)
    s_barrier
    ds_read_b128 v[16:19], v6 offset:40960
    ds_read_b64_tr_b16 v[32:33], v14 offset:40960
    ds_read_b64_tr_b16 v[34:35], v14 offset:42240
    ds_read_b64_tr_b16 v[36:37], v14 offset:41024
    ds_read_b64_tr_b16 v[38:39], v14 offset:42304
    v_mfma_f32_32x32x16_bf16 v[144:159], v[20:23], v[40:43], v[144:159]
    ds_read_b64_tr_b16 v[40:41], v14 offset:41088
    ds_read_b64_tr_b16 v[42:43], v14 offset:42368
    v_mfma_f32_32x32x16_bf16 v[208:223], v[20:23], v[44:47], v[208:223]
    ds_read_b64_tr_b16 v[44:45], v14 offset:41152
    ds_read_b64_tr_b16 v[46:47], v14 offset:42432
    v_mfma_f32_32x32x16_bf16 v[224:239], v[20:23], v[48:51], v[224:239]
    ds_read_b64_tr_b16 v[48:49], v14 offset:41216
    ds_read_b64_tr_b16 v[50:51], v14 offset:42496
    ds_read_b128 v[20:23], v7 offset:40960
    s_waitcnt lgkmcnt(9)
    v_mfma_f32_32x32x16_bf16 v[112:127], v[16:19], v[32:35], v[112:127]
    ds_read_b64_tr_b16 v[32:33], v14 offset:46080
    ds_read_b64_tr_b16 v[34:35], v14 offset:47360
    s_waitcnt lgkmcnt(9)
    v_mfma_f32_32x32x16_bf16 v[128:143], v[16:19], v[36:39], v[128:143]
    ds_read_b64_tr_b16 v[36:37], v14 offset:46144
    ds_read_b64_tr_b16 v[38:39], v14 offset:47424
    s_waitcnt lgkmcnt(9)
    v_mfma_f32_32x32x16_bf16 v[144:159], v[16:19], v[40:43], v[144:159]
    ds_read_b64_tr_b16 v[40:41], v14 offset:46208
    ds_read_b64_tr_b16 v[42:43], v14 offset:47488
    s_waitcnt lgkmcnt(9)
    v_mfma_f32_32x32x16_bf16 v[208:223], v[16:19], v[44:47], v[208:223]
    ds_read_b64_tr_b16 v[44:45], v14 offset:46272
    ds_read_b64_tr_b16 v[46:47], v14 offset:47552
    s_waitcnt lgkmcnt(9)
    v_mfma_f32_32x32x16_bf16 v[224:239], v[16:19], v[48:51], v[224:239]
    ds_read_b64_tr_b16 v[48:49], v14 offset:46336
    ds_read_b64_tr_b16 v[50:51], v14 offset:47616
    ds_read_b128 v[16:19], v8 offset:40960
    s_waitcnt lgkmcnt(9)
    v_mfma_f32_32x32x16_bf16 v[112:127], v[20:23], v[32:35], v[112:127]
    ds_read_b64_tr_b16 v[32:33], v14 offset:51200
    ds_read_b64_tr_b16 v[34:35], v14 offset:52480
    s_waitcnt lgkmcnt(9)
    v_mfma_f32_32x32x16_bf16 v[128:143], v[20:23], v[36:39], v[128:143]
    ds_read_b64_tr_b16 v[36:37], v14 offset:51264
    ds_read_b64_tr_b16 v[38:39], v14 offset:52544
    s_waitcnt lgkmcnt(9)
    v_mfma_f32_32x32x16_bf16 v[144:159], v[20:23], v[40:43], v[144:159]
    ds_read_b64_tr_b16 v[40:41], v14 offset:51328
    ds_read_b64_tr_b16 v[42:43], v14 offset:52608
    s_waitcnt lgkmcnt(9)
    v_mfma_f32_32x32x16_bf16 v[208:223], v[20:23], v[44:47], v[208:223]
    ds_read_b64_tr_b16 v[44:45], v14 offset:51392
    ds_read_b64_tr_b16 v[46:47], v14 offset:52672
    s_waitcnt lgkmcnt(9)
    v_mfma_f32_32x32x16_bf16 v[224:239], v[20:23], v[48:51], v[224:239]
    ds_read_b64_tr_b16 v[48:49], v14 offset:51456
    ds_read_b64_tr_b16 v[50:51], v14 offset:52736
    ds_read_b128 v[20:23], v9 offset:40960
    s_waitcnt lgkmcnt(9)
    v_mfma_f32_32x32x16_bf16 v[112:127], v[16:19], v[32:35], v[112:127]
    ds_read_b64_tr_b16 v[32:33], v14 offset:56320
    ds_read_b64_tr_b16 v[34:35], v14 offset:57600
    s_waitcnt lgkmcnt(9)
    v_mfma_f32_32x32x16_bf16 v[128:143], v[16:19], v[36:39], v[128:143]
    ds_read_b64_tr_b16 v[36:37], v14 offset:56384
    ds_read_b64_tr_b16 v[38:39], v14 offset:57664
    s_waitcnt lgkmcnt(9)
    v_mfma_f32_32x32x16_bf16 v[144:159], v[16:19], v[40:43], v[144:159]
    ds_read_b64_tr_b16 v[40:41], v14 offset:56448
    ds_read_b64_tr_b16 v[42:43], v14 offset:57728
    s_waitcnt lgkmcnt(9)
    v_mfma_f32_32x32x16_bf16 v[208:223], v[16:19], v[44:47], v[208:223]
    ds_read_b64_tr_b16 v[44:45], v14 offset:56512
    ds_read_b64_tr_b16 v[46:47], v14 offset:57792
    s_waitcnt lgkmcnt(9)
    v_mfma_f32_32x32x16_bf16 v[224:239], v[16:19], v[48:51], v[224:239]
    ds_read_b64_tr_b16 v[48:49], v14 offset:56576
    ds_read_b64_tr_b16 v[50:51], v14 offset:57856
    s_waitcnt lgkmcnt(8)
    v_mfma_f32_32x32x16_bf16 v[112:127], v[20:23], v[32:35], v[112:127]
    s_waitcnt lgkmcnt(6)
    v_mfma_f32_32x32x16_bf16 v[128:143], v[20:23], v[36:39], v[128:143]
    s_waitcnt lgkmcnt(0)
    s_barrier
    ds_read_b128 v[16:19], v10
    ds_read_b64_tr_b16 v[32:33], v15
    ds_read_b64_tr_b16 v[34:35], v15 offset:1280
    ds_read_b64_tr_b16 v[36:37], v15 offset:64
    ds_read_b64_tr_b16 v[38:39], v15 offset:1344
    v_mfma_f32_32x32x16_bf16 v[144:159], v[20:23], v[40:43], v[144:159]
    ds_read_b64_tr_b16 v[40:41], v15 offset:128
    ds_read_b64_tr_b16 v[42:43], v15 offset:1408
    v_mfma_f32_32x32x16_bf16 v[208:223], v[20:23], v[44:47], v[208:223]
    ds_read_b64_tr_b16 v[44:45], v15 offset:192
    ds_read_b64_tr_b16 v[46:47], v15 offset:1472
    v_mfma_f32_32x32x16_bf16 v[224:239], v[20:23], v[48:51], v[224:239]
    ds_read_b64_tr_b16 v[48:49], v15 offset:256
    ds_read_b64_tr_b16 v[50:51], v15 offset:1536
    v_cvt_pk_bf16_f32 v112, v112, v113
    v_cvt_pk_bf16_f32 v113, v114, v115
    v_cvt_pk_bf16_f32 v114, v116, v117
    v_cvt_pk_bf16_f32 v115, v118, v119
    v_cvt_pk_bf16_f32 v116, v120, v121
    v_cvt_pk_bf16_f32 v117, v122, v123
    v_cvt_pk_bf16_f32 v118, v124, v125
    v_cvt_pk_bf16_f32 v119, v126, v127
    v_mfma_f32_32x32x16_bf16 v[64:79], v[112:115], v[56:59], 0
    s_nop 0
    v_mfma_f32_32x32x16_bf16 v[64:79], v[116:119], v[60:63], v[64:79]
    v_cvt_pk_bf16_f32 v128, v128, v129
    v_cvt_pk_bf16_f32 v129, v130, v131
    v_cvt_pk_bf16_f32 v130, v132, v133
    v_cvt_pk_bf16_f32 v131, v134, v135
    v_cvt_pk_bf16_f32 v132, v136, v137
    v_cvt_pk_bf16_f32 v133, v138, v139
    v_cvt_pk_bf16_f32 v134, v140, v141
    v_cvt_pk_bf16_f32 v135, v142, v143
    v_mfma_f32_32x32x16_bf16 v[80:95], v[128:131], v[56:59], 0
    s_nop 0
    v_mfma_f32_32x32x16_bf16 v[80:95], v[132:135], v[60:63], v[80:95]
    v_cvt_pk_bf16_f32 v144, v144, v145
    v_cvt_pk_bf16_f32 v145, v146, v147
    v_cvt_pk_bf16_f32 v146, v148, v149
    v_cvt_pk_bf16_f32 v147, v150, v151
    v_cvt_pk_bf16_f32 v148, v152, v153
    v_cvt_pk_bf16_f32 v149, v154, v155
    v_cvt_pk_bf16_f32 v150, v156, v157
    v_cvt_pk_bf16_f32 v151, v158, v159
    v_mfma_f32_32x32x16_bf16 v[96:111], v[144:147], v[56:59], 0
    s_nop 0
    v_mfma_f32_32x32x16_bf16 v[96:111], v[148:151], v[60:63], v[96:111]
    v_cvt_pk_bf16_f32 v208, v208, v209
    v_cvt_pk_bf16_f32 v209, v210, v211
    v_cvt_pk_bf16_f32 v210, v212, v213
    v_cvt_pk_bf16_f32 v211, v214, v215
    v_cvt_pk_bf16_f32 v212, v216, v217
    v_cvt_pk_bf16_f32 v213, v218, v219
    v_cvt_pk_bf16_f32 v214, v220, v221
    v_cvt_pk_bf16_f32 v215, v222, v223
    v_mfma_f32_32x32x16_bf16 v[160:175], v[208:211], v[56:59], 0
    s_nop 0
    v_mfma_f32_32x32x16_bf16 v[160:175], v[212:215], v[60:63], v[160:175]
    v_cvt_pk_bf16_f32 v224, v224, v225
    v_cvt_pk_bf16_f32 v225, v226, v227
    v_cvt_pk_bf16_f32 v226, v228, v229
    v_cvt_pk_bf16_f32 v227, v230, v231
    v_cvt_pk_bf16_f32 v228, v232, v233
    v_cvt_pk_bf16_f32 v229, v234, v235
    v_cvt_pk_bf16_f32 v230, v236, v237
    v_cvt_pk_bf16_f32 v231, v238, v239
    v_mfma_f32_32x32x16_bf16 v[176:191], v[224:227], v[56:59], 0
    s_nop 0
    v_mfma_f32_32x32x16_bf16 v[176:191], v[228:231], v[60:63], v[176:191]
    ds_read_b128 v[20:23], v11
    s_waitcnt lgkmcnt(9)
    v_mfma_f32_32x32x16_bf16 v[112:127], v[16:19], v[32:35], 0
    ds_read_b64_tr_b16 v[32:33], v15 offset:5120
    ds_read_b64_tr_b16 v[34:35], v15 offset:6400
    s_waitcnt lgkmcnt(9)
    v_mfma_f32_32x32x16_bf16 v[128:143], v[16:19], v[36:39], 0
    ds_read_b64_tr_b16 v[36:37], v15 offset:5184
    ds_read_b64_tr_b16 v[38:39], v15 offset:6464
    s_waitcnt lgkmcnt(9)
    v_mfma_f32_32x32x16_bf16 v[144:159], v[16:19], v[40:43], 0
    ds_read_b64_tr_b16 v[40:41], v15 offset:5248
    ds_read_b64_tr_b16 v[42:43], v15 offset:6528
    s_waitcnt lgkmcnt(9)
    v_mfma_f32_32x32x16_bf16 v[208:223], v[16:19], v[44:47], 0
    ds_read_b64_tr_b16 v[44:45], v15 offset:5312
    ds_read_b64_tr_b16 v[46:47], v15 offset:6592
    s_waitcnt lgkmcnt(9)
    v_mfma_f32_32x32x16_bf16 v[224:239], v[16:19], v[48:51], 0
    ds_read_b64_tr_b16 v[48:49], v15 offset:5376
    ds_read_b64_tr_b16 v[50:51], v15 offset:6656
    ds_read_b128 v[16:19], v12
    s_waitcnt lgkmcnt(9)
    v_mfma_f32_32x32x16_bf16 v[112:127], v[20:23], v[32:35], v[112:127]
    ds_read_b64_tr_b16 v[32:33], v15 offset:10240
    ds_read_b64_tr_b16 v[34:35], v15 offset:11520
    s_waitcnt lgkmcnt(9)
    v_mfma_f32_32x32x16_bf16 v[128:143], v[20:23], v[36:39], v[128:143]
    ds_read_b64_tr_b16 v[36:37], v15 offset:10304
    ds_read_b64_tr_b16 v[38:39], v15 offset:11584
    s_waitcnt lgkmcnt(9)
    v_mfma_f32_32x32x16_bf16 v[144:159], v[20:23], v[40:43], v[144:159]
    ds_read_b64_tr_b16 v[40:41], v15 offset:10368
    ds_read_b64_tr_b16 v[42:43], v15 offset:11648
    s_waitcnt lgkmcnt(9)
    v_mfma_f32_32x32x16_bf16 v[208:223], v[20:23], v[44:47], v[208:223]
    ds_read_b64_tr_b16 v[44:45], v15 offset:10432
    ds_read_b64_tr_b16 v[46:47], v15 offset:11712
    s_waitcnt lgkmcnt(9)
    v_mfma_f32_32x32x16_bf16 v[224:239], v[20:23], v[48:51], v[224:239]
    ds_read_b64_tr_b16 v[48:49], v15 offset:10496
    ds_read_b64_tr_b16 v[50:51], v15 offset:11776
    ds_read_b128 v[20:23], v13
    s_waitcnt lgkmcnt(9)
    v_mfma_f32_32x32x16_bf16 v[112:127], v[16:19], v[32:35], v[112:127]
    ds_read_b64_tr_b16 v[32:33], v15 offset:15360
    ds_read_b64_tr_b16 v[34:35], v15 offset:16640
    s_waitcnt lgkmcnt(9)
    v_mfma_f32_32x32x16_bf16 v[128:143], v[16:19], v[36:39], v[128:143]
    ds_read_b64_tr_b16 v[36:37], v15 offset:15424
    ds_read_b64_tr_b16 v[38:39], v15 offset:16704
    s_waitcnt lgkmcnt(9)
    v_mfma_f32_32x32x16_bf16 v[144:159], v[16:19], v[40:43], v[144:159]
    ds_read_b64_tr_b16 v[40:41], v15 offset:15488
    ds_read_b64_tr_b16 v[42:43], v15 offset:16768
    s_waitcnt lgkmcnt(9)
    v_mfma_f32_32x32x16_bf16 v[208:223], v[16:19], v[44:47], v[208:223]
    ds_read_b64_tr_b16 v[44:45], v15 offset:15552
    ds_read_b64_tr_b16 v[46:47], v15 offset:16832
    s_waitcnt lgkmcnt(9)
    v_mfma_f32_32x32x16_bf16 v[224:239], v[16:19], v[48:51], v[224:239]
    ds_read_b64_tr_b16 v[48:49], v15 offset:15616
    ds_read_b64_tr_b16 v[50:51], v15 offset:16896
    s_waitcnt lgkmcnt(8)
    v_mfma_f32_32x32x16_bf16 v[112:127], v[20:23], v[32:35], v[112:127]
    s_waitcnt lgkmcnt(6)
    v_mfma_f32_32x32x16_bf16 v[128:143], v[20:23], v[36:39], v[128:143]
    s_waitcnt lgkmcnt(0)
    s_barrier
    ds_read_b128 v[16:19], v6
    ds_read_b64_tr_b16 v[32:33], v14
    ds_read_b64_tr_b16 v[34:35], v14 offset:1280
    ds_read_b64_tr_b16 v[36:37], v14 offset:64
    ds_read_b64_tr_b16 v[38:39], v14 offset:1344
    v_mfma_f32_32x32x16_bf16 v[144:159], v[20:23], v[40:43], v[144:159]
    ds_read_b64_tr_b16 v[40:41], v14 offset:128
    ds_read_b64_tr_b16 v[42:43], v14 offset:1408
    v_mfma_f32_32x32x16_bf16 v[208:223], v[20:23], v[44:47], v[208:223]
    ds_read_b64_tr_b16 v[44:45], v14 offset:192
    ds_read_b64_tr_b16 v[46:47], v14 offset:1472
    v_mfma_f32_32x32x16_bf16 v[224:239], v[20:23], v[48:51], v[224:239]
    ds_read_b64_tr_b16 v[48:49], v14 offset:256
    ds_read_b64_tr_b16 v[50:51], v14 offset:1536
    s_add_u32 s3, s41, 1
    s_and_b32 s3, s3, 3
    s_lshl_b32 s3, s3, 14
    s_add_u32 s53, s3, s45
    buffer_load_dwordx4 v[24:27], v31, s[32:35], s53 offen sc1
    buffer_load_dwordx4 v[200:203], v31, s[32:35], s53 offen offset:1024 sc1
    buffer_load_dwordx4 v[204:207], v31, s[32:35], s53 offen offset:2048 sc1
    buffer_load_dwordx4 v[52:55], v31, s[32:35], s53 offen offset:3072 sc1
    ds_read_b128 v[20:23], v7
    s_waitcnt lgkmcnt(9)
    v_mfma_f32_32x32x16_bf16 v[112:127], v[16:19], v[32:35], v[112:127]
    ds_read_b64_tr_b16 v[32:33], v14 offset:5120
    ds_read_b64_tr_b16 v[34:35], v14 offset:6400
    s_waitcnt lgkmcnt(9)
    v_mfma_f32_32x32x16_bf16 v[128:143], v[16:19], v[36:39], v[128:143]
    ds_read_b64_tr_b16 v[36:37], v14 offset:5184
    ds_read_b64_tr_b16 v[38:39], v14 offset:6464
    s_waitcnt lgkmcnt(9)
    v_mfma_f32_32x32x16_bf16 v[144:159], v[16:19], v[40:43], v[144:159]
    ds_read_b64_tr_b16 v[40:41], v14 offset:5248
    ds_read_b64_tr_b16 v[42:43], v14 offset:6528
    s_waitcnt lgkmcnt(9)
    v_mfma_f32_32x32x16_bf16 v[208:223], v[16:19], v[44:47], v[208:223]
    ds_read_b64_tr_b16 v[44:45], v14 offset:5312
    ds_read_b64_tr_b16 v[46:47], v14 offset:6592
    s_waitcnt lgkmcnt(9)
    v_mfma_f32_32x32x16_bf16 v[224:239], v[16:19], v[48:51], v[224:239]
    ds_read_b64_tr_b16 v[48:49], v14 offset:5376
    ds_read_b64_tr_b16 v[50:51], v14 offset:6656
    ds_read_b128 v[16:19], v8
    s_waitcnt lgkmcnt(9)
    v_mfma_f32_32x32x16_bf16 v[112:127], v[20:23], v[32:35], v[112:127]
    ds_read_b64_tr_b16 v[32:33], v14 offset:10240
    ds_read_b64_tr_b16 v[34:35], v14 offset:11520
    s_waitcnt lgkmcnt(9)
    v_mfma_f32_32x32x16_bf16 v[128:143], v[20:23], v[36:39], v[128:143]
    ds_read_b64_tr_b16 v[36:37], v14 offset:10304
    ds_read_b64_tr_b16 v[38:39], v14 offset:11584
    s_waitcnt lgkmcnt(9)
    v_mfma_f32_32x32x16_bf16 v[144:159], v[20:23], v[40:43], v[144:159]
    ds_read_b64_tr_b16 v[40:41], v14 offset:10368
    ds_read_b64_tr_b16 v[42:43], v14 offset:11648
    s_waitcnt lgkmcnt(9)
    v_mfma_f32_32x32x16_bf16 v[208:223], v[20:23], v[44:47], v[208:223]
    ds_read_b64_tr_b16 v[44:45], v14 offset:10432
    ds_read_b64_tr_b16 v[46:47], v14 offset:11712
    s_waitcnt lgkmcnt(9)
    v_mfma_f32_32x32x16_bf16 v[224:239], v[20:23], v[48:51], v[224:239]
    ds_read_b64_tr_b16 v[48:49], v14 offset:10496
    ds_read_b64_tr_b16 v[50:51], v14 offset:11776
    ds_read_b128 v[20:23], v9
    s_waitcnt lgkmcnt(9)
    v_mfma_f32_32x32x16_bf16 v[112:127], v[16:19], v[32:35], v[112:127]
    ds_read_b64_tr_b16 v[32:33], v14 offset:15360
    ds_read_b64_tr_b16 v[34:35], v14 offset:16640
    s_waitcnt lgkmcnt(9)
    v_mfma_f32_32x32x16_bf16 v[128:143], v[16:19], v[36:39], v[128:143]
    ds_read_b64_tr_b16 v[36:37], v14 offset:15424
    ds_read_b64_tr_b16 v[38:39], v14 offset:16704
    s_waitcnt lgkmcnt(9)
    v_mfma_f32_32x32x16_bf16 v[144:159], v[16:19], v[40:43], v[144:159]
    ds_read_b64_tr_b16 v[40:41], v14 offset:15488
    ds_read_b64_tr_b16 v[42:43], v14 offset:16768
    s_waitcnt lgkmcnt(9)
    v_mfma_f32_32x32x16_bf16 v[208:223], v[16:19], v[44:47], v[208:223]
    ds_read_b64_tr_b16 v[44:45], v14 offset:15552
    ds_read_b64_tr_b16 v[46:47], v14 offset:16832
    s_waitcnt lgkmcnt(9)
    v_mfma_f32_32x32x16_bf16 v[224:239], v[16:19], v[48:51], v[224:239]
    ds_read_b64_tr_b16 v[48:49], v14 offset:15616
    ds_read_b64_tr_b16 v[50:51], v14 offset:16896
    s_waitcnt lgkmcnt(8)
    v_mfma_f32_32x32x16_bf16 v[112:127], v[20:23], v[32:35], v[112:127]
    s_waitcnt lgkmcnt(6)
    v_mfma_f32_32x32x16_bf16 v[128:143], v[20:23], v[36:39], v[128:143]
    s_waitcnt lgkmcnt(0)
    s_barrier
    ds_read_b128 v[16:19], v10 offset:40960
    ds_read_b64_tr_b16 v[32:33], v15 offset:40960
    ds_read_b64_tr_b16 v[34:35], v15 offset:42240
    ds_read_b64_tr_b16 v[36:37], v15 offset:41024
    ds_read_b64_tr_b16 v[38:39], v15 offset:42304
    v_mfma_f32_32x32x16_bf16 v[144:159], v[20:23], v[40:43], v[144:159]
    ds_read_b64_tr_b16 v[40:41], v15 offset:41088
    ds_read_b64_tr_b16 v[42:43], v15 offset:42368
    v_mfma_f32_32x32x16_bf16 v[208:223], v[20:23], v[44:47], v[208:223]
    ds_read_b64_tr_b16 v[44:45], v15 offset:41152
    ds_read_b64_tr_b16 v[46:47], v15 offset:42432
    v_mfma_f32_32x32x16_bf16 v[224:239], v[20:23], v[48:51], v[224:239]
    ds_read_b64_tr_b16 v[48:49], v15 offset:41216
    ds_read_b64_tr_b16 v[50:51], v15 offset:42496
    ds_read_b128 v[20:23], v11 offset:40960
    s_waitcnt lgkmcnt(9)
    v_mfma_f32_32x32x16_bf16 v[112:127], v[16:19], v[32:35], v[112:127]
    ds_read_b64_tr_b16 v[32:33], v15 offset:46080
    ds_read_b64_tr_b16 v[34:35], v15 offset:47360
    s_waitcnt lgkmcnt(9)
    v_mfma_f32_32x32x16_bf16 v[128:143], v[16:19], v[36:39], v[128:143]
    ds_read_b64_tr_b16 v[36:37], v15 offset:46144
    ds_read_b64_tr_b16 v[38:39], v15 offset:47424
    s_waitcnt lgkmcnt(9)
    v_mfma_f32_32x32x16_bf16 v[144:159], v[16:19], v[40:43], v[144:159]
    ds_read_b64_tr_b16 v[40:41], v15 offset:46208
    ds_read_b64_tr_b16 v[42:43], v15 offset:47488
    s_waitcnt lgkmcnt(9)
    v_mfma_f32_32x32x16_bf16 v[208:223], v[16:19], v[44:47], v[208:223]
    ds_read_b64_tr_b16 v[44:45], v15 offset:46272
    ds_read_b64_tr_b16 v[46:47], v15 offset:47552
    s_waitcnt lgkmcnt(9)
    v_mfma_f32_32x32x16_bf16 v[224:239], v[16:19], v[48:51], v[224:239]
    ds_read_b64_tr_b16 v[48:49], v15 offset:46336
    ds_read_b64_tr_b16 v[50:51], v15 offset:47616
    ds_read_b128 v[16:19], v12 offset:40960
    s_waitcnt lgkmcnt(9)
    v_mfma_f32_32x32x16_bf16 v[112:127], v[20:23], v[32:35], v[112:127]
    ds_read_b64_tr_b16 v[32:33], v15 offset:51200
    ds_read_b64_tr_b16 v[34:35], v15 offset:52480
    s_waitcnt lgkmcnt(9)
    v_mfma_f32_32x32x16_bf16 v[128:143], v[20:23], v[36:39], v[128:143]
    ds_read_b64_tr_b16 v[36:37], v15 offset:51264
    ds_read_b64_tr_b16 v[38:39], v15 offset:52544
    s_waitcnt lgkmcnt(9)
    v_mfma_f32_32x32x16_bf16 v[144:159], v[20:23], v[40:43], v[144:159]
    ds_read_b64_tr_b16 v[40:41], v15 offset:51328
    ds_read_b64_tr_b16 v[42:43], v15 offset:52608
    s_waitcnt lgkmcnt(9)
    v_mfma_f32_32x32x16_bf16 v[208:223], v[20:23], v[44:47], v[208:223]
    ds_read_b64_tr_b16 v[44:45], v15 offset:51392
    ds_read_b64_tr_b16 v[46:47], v15 offset:52672
    s_waitcnt lgkmcnt(9)
    v_mfma_f32_32x32x16_bf16 v[224:239], v[20:23], v[48:51], v[224:239]
    ds_read_b64_tr_b16 v[48:49], v15 offset:51456
    ds_read_b64_tr_b16 v[50:51], v15 offset:52736
    ds_read_b128 v[20:23], v13 offset:40960
    s_waitcnt lgkmcnt(9)
    v_mfma_f32_32x32x16_bf16 v[112:127], v[16:19], v[32:35], v[112:127]
    ds_read_b64_tr_b16 v[32:33], v15 offset:56320
    ds_read_b64_tr_b16 v[34:35], v15 offset:57600
    s_waitcnt lgkmcnt(9)
    v_mfma_f32_32x32x16_bf16 v[128:143], v[16:19], v[36:39], v[128:143]
    ds_read_b64_tr_b16 v[36:37], v15 offset:56384
    ds_read_b64_tr_b16 v[38:39], v15 offset:57664
    s_waitcnt lgkmcnt(9)
    v_mfma_f32_32x32x16_bf16 v[144:159], v[16:19], v[40:43], v[144:159]
    ds_read_b64_tr_b16 v[40:41], v15 offset:56448
    ds_read_b64_tr_b16 v[42:43], v15 offset:57728
    s_waitcnt lgkmcnt(9)
    v_mfma_f32_32x32x16_bf16 v[208:223], v[16:19], v[44:47], v[208:223]
    ds_read_b64_tr_b16 v[44:45], v15 offset:56512
    ds_read_b64_tr_b16 v[46:47], v15 offset:57792
    s_waitcnt lgkmcnt(9)
    v_mfma_f32_32x32x16_bf16 v[224:239], v[16:19], v[48:51], v[224:239]
    ds_read_b64_tr_b16 v[48:49], v15 offset:56576
    ds_read_b64_tr_b16 v[50:51], v15 offset:57856
    s_mov_b32 s50, 0
    s_waitcnt vmcnt(0)
    s_branch L_chkP1_c
L_chkP1:
    buffer_load_dwordx4 v[24:27], v31, s[32:35], s53 offen sc1
    buffer_load_dwordx4 v[200:203], v31, s[32:35], s53 offen offset:1024 sc1
    buffer_load_dwordx4 v[204:207], v31, s[32:35], s53 offen offset:2048 sc1
    buffer_load_dwordx4 v[52:55], v31, s[32:35], s53 offen offset:3072 sc1
    s_waitcnt vmcnt(0)
L_chkP1_c:
    v_xor_b32 v28, s47, v25
    v_xor_b32 v29, s47, v27
    v_or_b32 v28, v28, v29
    v_xor_b32 v29, s47, v201
    v_or_b32 v28, v28, v29
    v_xor_b32 v29, s47, v203
    v_or_b32 v28, v28, v29
    v_xor_b32 v29, s47, v205
    v_or_b32 v28, v28, v29
    v_xor_b32 v29, s47, v207
    v_or_b32 v28, v28, v29
    v_xor_b32 v29, s47, v53
    v_or_b32 v28, v28, v29
    v_xor_b32 v29, s47, v55
    v_or_b32 v28, v28, v29
    v_cmp_ne_u32 vcc, 0, v28
    s_add_u32 s50, s50, 1
    s_cmp_gt_u32 s50, 200000
    s_cbranch_scc1 L_chkP1_d
    s_nop 0
    s_cmp_lg_u64 vcc, 0
    s_cbranch_scc1 L_chkP1
L_chkP1_d:
    v_mov_b32 v240, v24
    v_mov_b32 v241, v26
    v_mov_b32 v242, v200
    v_mov_b32 v243, v202
    v_mov_b32 v244, v204
    v_mov_b32 v245, v206
    v_mov_b32 v246, v52
    v_mov_b32 v247, v54
    s_waitcnt lgkmcnt(8)
    v_mfma_f32_32x32x16_bf16 v[112:127], v[20:23], v[32:35], v[112:127]
    s_waitcnt lgkmcnt(6)
    v_mfma_f32_32x32x16_bf16 v[128:143], v[20:23], v[36:39], v[128:143]
    s_waitcnt lgkmcnt(0)
    s_barrier
    ds_read_b128 v[16:19], v6 offset:40960
    ds_read_b64_tr_b16 v[32:33], v14 offset:40960
    ds_read_b64_tr_b16 v[34:35], v14 offset:42240
    ds_read_b64_tr_b16 v[36:37], v14 offset:41024
    ds_read_b64_tr_b16 v[38:39], v14 offset:42304
    v_mfma_f32_32x32x16_bf16 v[144:159], v[20:23], v[40:43], v[144:159]
    ds_read_b64_tr_b16 v[40:41], v14 offset:41088
    ds_read_b64_tr_b16 v[42:43], v14 offset:42368
    v_mfma_f32_32x32x16_bf16 v[208:223], v[20:23], v[44:47], v[208:223]
    ds_read_b64_tr_b16 v[44:45], v14 offset:41152
    ds_read_b64_tr_b16 v[46:47], v14 offset:42432
    v_mfma_f32_32x32x16_bf16 v[224:239], v[20:23], v[48:51], v[224:239]
    ds_read_b64_tr_b16 v[48:49], v14 offset:41216
    ds_read_b64_tr_b16 v[50:51], v14 offset:42496
    v_cvt_pk_bf16_f32 v112, v112, v113
    v_cvt_pk_bf16_f32 v113, v114, v115
    v_cvt_pk_bf16_f32 v114, v116, v117
    v_cvt_pk_bf16_f32 v115, v118, v119
    v_cvt_pk_bf16_f32 v116, v120, v121
    v_cvt_pk_bf16_f32 v117, v122, v123
    v_cvt_pk_bf16_f32 v118, v124, v125
    v_cvt_pk_bf16_f32 v119, v126, v127
    v_mfma_f32_32x32x16_bf16 v[64:79], v[112:115], v[240:243], v[64:79]
    s_nop 0
    v_mfma_f32_32x32x16_bf16 v[64:79], v[116:119], v[244:247], v[64:79]
    v_cvt_pk_bf16_f32 v128, v128, v129
    v_cvt_pk_bf16_f32 v129, v130, v131
    v_cvt_pk_bf16_f32 v130, v132, v133
    v_cvt_pk_bf16_f32 v131, v134, v135
    v_cvt_pk_bf16_f32 v132, v136, v137
    v_cvt_pk_bf16_f32 v133, v138, v139
    v_cvt_pk_bf16_f32 v134, v140, v141
    v_cvt_pk_bf16_f32 v135, v142, v143
    v_mfma_f32_32x32x16_bf16 v[80:95], v[128:131], v[240:243], v[80:95]
    s_nop 0
    v_mfma_f32_32x32x16_bf16 v[80:95], v[132:135], v[244:247], v[80:95]
    v_cvt_pk_bf16_f32 v144, v144, v145
    v_cvt_pk_bf16_f32 v145, v146, v147
    v_cvt_pk_bf16_f32 v146, v148, v149
    v_cvt_pk_bf16_f32 v147, v150, v151
    v_cvt_pk_bf16_f32 v148, v152, v153
    v_cvt_pk_bf16_f32 v149, v154, v155
    v_cvt_pk_bf16_f32 v150, v156, v157
    v_cvt_pk_bf16_f32 v151, v158, v159
    v_mfma_f32_32x32x16_bf16 v[96:111], v[144:147], v[240:243], v[96:111]
    s_nop 0
    v_mfma_f32_32x32x16_bf16 v[96:111], v[148:151], v[244:247], v[96:111]
    v_cvt_pk_bf16_f32 v208, v208, v209
    v_cvt_pk_bf16_f32 v209, v210, v211
    v_cvt_pk_bf16_f32 v210, v212, v213
    v_cvt_pk_bf16_f32 v211, v214, v215
    v_cvt_pk_bf16_f32 v212, v216, v217
    v_cvt_pk_bf16_f32 v213, v218, v219
    v_cvt_pk_bf16_f32 v214, v220, v221
    v_cvt_pk_bf16_f32 v215, v222, v223
    v_mfma_f32_32x32x16_bf16 v[160:175], v[208:211], v[240:243], v[160:175]
    s_nop 0
    v_mfma_f32_32x32x16_bf16 v[160:175], v[212:215], v[244:247], v[160:175]
    v_cvt_pk_bf16_f32 v224, v224, v225
    v_cvt_pk_bf16_f32 v225, v226, v227
    v_cvt_pk_bf16_f32 v226, v228, v229
    v_cvt_pk_bf16_f32 v227, v230, v231
    v_cvt_pk_bf16_f32 v228, v232, v233
    v_cvt_pk_bf16_f32 v229, v234, v235
    v_cvt_pk_bf16_f32 v230, v236, v237
    v_cvt_pk_bf16_f32 v231, v238, v239
    v_mfma_f32_32x32x16_bf16 v[176:191], v[224:227], v[240:243], v[176:191]
    s_nop 0
    v_mfma_f32_32x32x16_bf16 v[176:191], v[228:231], v[244:247], v[176:191]
    ds_read_b128 v[20:23], v7 offset:40960
    s_waitcnt lgkmcnt(9)
    v_mfma_f32_32x32x16_bf16 v[112:127], v[16:19], v[32:35], 0
    ds_read_b64_tr_b16 v[32:33], v14 offset:46080
    ds_read_b64_tr_b16 v[34:35], v14 offset:47360
    s_waitcnt lgkmcnt(9)
    v_mfma_f32_32x32x16_bf16 v[128:143], v[16:19], v[36:39], 0
    ds_read_b64_tr_b16 v[36:37], v14 offset:46144
    ds_read_b64_tr_b16 v[38:39], v14 offset:47424
    s_waitcnt lgkmcnt(9)
    v_mfma_f32_32x32x16_bf16 v[144:159], v[16:19], v[40:43], 0
    ds_read_b64_tr_b16 v[40:41], v14 offset:46208
    ds_read_b64_tr_b16 v[42:43], v14 offset:47488
    s_waitcnt lgkmcnt(9)
    v_mfma_f32_32x32x16_bf16 v[208:223], v[16:19], v[44:47], 0
    ds_read_b64_tr_b16 v[44:45], v14 offset:46272
    ds_read_b64_tr_b16 v[46:47], v14 offset:47552
    s_waitcnt lgkmcnt(9)
    v_mfma_f32_32x32x16_bf16 v[224:239], v[16:19], v[48:51], 0
    ds_read_b64_tr_b16 v[48:49], v14 offset:46336
    ds_read_b64_tr_b16 v[50:51], v14 offset:47616
    ds_read_b128 v[16:19], v8 offset:40960
    s_waitcnt lgkmcnt(9)
    v_mfma_f32_32x32x16_bf16 v[112:127], v[20:23], v[32:35], v[112:127]
    ds_read_b64_tr_b16 v[32:33], v14 offset:51200
    ds_read_b64_tr_b16 v[34:35], v14 offset:52480
    s_waitcnt lgkmcnt(9)
    v_mfma_f32_32x32x16_bf16 v[128:143], v[20:23], v[36:39], v[128:143]
    ds_read_b64_tr_b16 v[36:37], v14 offset:51264
    ds_read_b64_tr_b16 v[38:39], v14 offset:52544
    s_waitcnt lgkmcnt(9)
    v_mfma_f32_32x32x16_bf16 v[144:159], v[20:23], v[40:43], v[144:159]
    ds_read_b64_tr_b16 v[40:41], v14 offset:51328
    ds_read_b64_tr_b16 v[42:43], v14 offset:52608
    s_waitcnt lgkmcnt(9)
    v_mfma_f32_32x32x16_bf16 v[208:223], v[20:23], v[44:47], v[208:223]
    ds_read_b64_tr_b16 v[44:45], v14 offset:51392
    ds_read_b64_tr_b16 v[46:47], v14 offset:52672
    s_waitcnt lgkmcnt(9)
    v_mfma_f32_32x32x16_bf16 v[224:239], v[20:23], v[48:51], v[224:239]
    ds_read_b64_tr_b16 v[48:49], v14 offset:51456
    ds_read_b64_tr_b16 v[50:51], v14 offset:52736
    ds_read_b128 v[20:23], v9 offset:40960
    s_waitcnt lgkmcnt(9)
    v_mfma_f32_32x32x16_bf16 v[112:127], v[16:19], v[32:35], v[112:127]
    ds_read_b64_tr_b16 v[32:33], v14 offset:56320
    ds_read_b64_tr_b16 v[34:35], v14 offset:57600
    s_waitcnt lgkmcnt(9)
    v_mfma_f32_32x32x16_bf16 v[128:143], v[16:19], v[36:39], v[128:143]
    ds_read_b64_tr_b16 v[36:37], v14 offset:56384
    ds_read_b64_tr_b16 v[38:39], v14 offset:57664
    s_waitcnt lgkmcnt(9)
    v_mfma_f32_32x32x16_bf16 v[144:159], v[16:19], v[40:43], v[144:159]
    ds_read_b64_tr_b16 v[40:41], v14 offset:56448
    ds_read_b64_tr_b16 v[42:43], v14 offset:57728
    s_waitcnt lgkmcnt(9)
    v_mfma_f32_32x32x16_bf16 v[208:223], v[16:19], v[44:47], v[208:223]
    ds_read_b64_tr_b16 v[44:45], v14 offset:56512
    ds_read_b64_tr_b16 v[46:47], v14 offset:57792
    s_waitcnt lgkmcnt(9)
    v_mfma_f32_32x32x16_bf16 v[224:239], v[16:19], v[48:51], v[224:239]
    ds_read_b64_tr_b16 v[48:49], v14 offset:56576
    ds_read_b64_tr_b16 v[50:51], v14 offset:57856
    s_waitcnt lgkmcnt(8)
    v_mfma_f32_32x32x16_bf16 v[112:127], v[20:23], v[32:35], v[112:127]
    s_waitcnt lgkmcnt(6)
    v_mfma_f32_32x32x16_bf16 v[128:143], v[20:23], v[36:39], v[128:143]
    s_waitcnt lgkmcnt(0)
    s_barrier
    ds_read_b128 v[16:19], v10
    ds_read_b64_tr_b16 v[32:33], v15
    ds_read_b64_tr_b16 v[34:35], v15 offset:1280
    ds_read_b64_tr_b16 v[36:37], v15 offset:64
    ds_read_b64_tr_b16 v[38:39], v15 offset:1344
    v_mfma_f32_32x32x16_bf16 v[144:159], v[20:23], v[40:43], v[144:159]
    ds_read_b64_tr_b16 v[40:41], v15 offset:128
    ds_read_b64_tr_b16 v[42:43], v15 offset:1408
    v_mfma_f32_32x32x16_bf16 v[208:223], v[20:23], v[44:47], v[208:223]
    ds_read_b64_tr_b16 v[44:45], v15 offset:192
    ds_read_b64_tr_b16 v[46:47], v15 offset:1472
    v_mfma_f32_32x32x16_bf16 v[224:239], v[20:23], v[48:51], v[224:239]
    ds_read_b64_tr_b16 v[48:49], v15 offset:256
    ds_read_b64_tr_b16 v[50:51], v15 offset:1536
    s_add_u32 s3, s41, 2
    s_and_b32 s3, s3, 3
    s_lshl_b32 s3, s3, 14
    s_add_u32 s53, s3, s45
    buffer_load_dwordx4 v[24:27], v31, s[32:35], s53 offen sc1
    buffer_load_dwordx4 v[200:203], v31, s[32:35], s53 offen offset:1024 sc1
    buffer_load_dwordx4 v[204:207], v31, s[32:35], s53 offen offset:2048 sc1
    buffer_load_dwordx4 v[52:55], v31, s[32:35], s53 offen offset:3072 sc1
    ds_read_b128 v[20:23], v11
    s_waitcnt lgkmcnt(9)
    v_mfma_f32_32x32x16_bf16 v[112:127], v[16:19], v[32:35], v[112:127]
    ds_read_b64_tr_b16 v[32:33], v15 offset:5120
    ds_read_b64_tr_b16 v[34:35], v15 offset:6400
    s_waitcnt lgkmcnt(9)
    v_mfma_f32_32x32x16_bf16 v[128:143], v[16:19], v[36:39], v[128:143]
    ds_read_b64_tr_b16 v[36:37], v15 offset:5184
    ds_read_b64_tr_b16 v[38:39], v15 offset:6464
    s_waitcnt lgkmcnt(9)
    v_mfma_f32_32x32x16_bf16 v[144:159], v[16:19], v[40:43], v[144:159]
    ds_read_b64_tr_b16 v[40:41], v15 offset:5248
    ds_read_b64_tr_b16 v[42:43], v15 offset:6528
    s_waitcnt lgkmcnt(9)
    v_mfma_f32_32x32x16_bf16 v[208:223], v[16:19], v[44:47], v[208:223]
    ds_read_b64_tr_b16 v[44:45], v15 offset:5312
    ds_read_b64_tr_b16 v[46:47], v15 offset:6592
    s_waitcnt lgkmcnt(9)
    v_mfma_f32_32x32x16_bf16 v[224:239], v[16:19], v[48:51], v[224:239]
    ds_read_b64_tr_b16 v[48:49], v15 offset:5376
    ds_read_b64_tr_b16 v[50:51], v15 offset:6656
    ds_read_b128 v[16:19], v12
    s_waitcnt lgkmcnt(9)
    v_mfma_f32_32x32x16_bf16 v[112:127], v[20:23], v[32:35], v[112:127]
    ds_read_b64_tr_b16 v[32:33], v15 offset:10240
    ds_read_b64_tr_b16 v[34:35], v15 offset:11520
    s_waitcnt lgkmcnt(9)
    v_mfma_f32_32x32x16_bf16 v[128:143], v[20:23], v[36:39], v[128:143]
    ds_read_b64_tr_b16 v[36:37], v15 offset:10304
    ds_read_b64_tr_b16 v[38:39], v15 offset:11584
    s_waitcnt lgkmcnt(9)
    v_mfma_f32_32x32x16_bf16 v[144:159], v[20:23], v[40:43], v[144:159]
    ds_read_b64_tr_b16 v[40:41], v15 offset:10368
    ds_read_b64_tr_b16 v[42:43], v15 offset:11648
    s_waitcnt lgkmcnt(9)
    v_mfma_f32_32x32x16_bf16 v[208:223], v[20:23], v[44:47], v[208:223]
    ds_read_b64_tr_b16 v[44:45], v15 offset:10432
    ds_read_b64_tr_b16 v[46:47], v15 offset:11712
    s_waitcnt lgkmcnt(9)
    v_mfma_f32_32x32x16_bf16 v[224:239], v[20:23], v[48:51], v[224:239]
    ds_read_b64_tr_b16 v[48:49], v15 offset:10496
    ds_read_b64_tr_b16 v[50:51], v15 offset:11776
    ds_read_b128 v[20:23], v13
    s_waitcnt lgkmcnt(9)
    v_mfma_f32_32x32x16_bf16 v[112:127], v[16:19], v[32:35], v[112:127]
    ds_read_b64_tr_b16 v[32:33], v15 offset:15360
    ds_read_b64_tr_b16 v[34:35], v15 offset:16640
    s_waitcnt lgkmcnt(9)
    v_mfma_f32_32x32x16_bf16 v[128:143], v[16:19], v[36:39], v[128:143]
    ds_read_b64_tr_b16 v[36:37], v15 offset:15424
    ds_read_b64_tr_b16 v[38:39], v15 offset:16704
    s_waitcnt lgkmcnt(9)
    v_mfma_f32_32x32x16_bf16 v[144:159], v[16:19], v[40:43], v[144:159]
    ds_read_b64_tr_b16 v[40:41], v15 offset:15488
    ds_read_b64_tr_b16 v[42:43], v15 offset:16768
    s_waitcnt lgkmcnt(9)
    v_mfma_f32_32x32x16_bf16 v[208:223], v[16:19], v[44:47], v[208:223]
    ds_read_b64_tr_b16 v[44:45], v15 offset:15552
    ds_read_b64_tr_b16 v[46:47], v15 offset:16832
    s_waitcnt lgkmcnt(9)
    v_mfma_f32_32x32x16_bf16 v[224:239], v[16:19], v[48:51], v[224:239]
    ds_read_b64_tr_b16 v[48:49], v15 offset:15616
    ds_read_b64_tr_b16 v[50:51], v15 offset:16896
    s_waitcnt lgkmcnt(8)
    v_mfma_f32_32x32x16_bf16 v[112:127], v[20:23], v[32:35], v[112:127]
    s_waitcnt lgkmcnt(6)
    v_mfma_f32_32x32x16_bf16 v[128:143], v[20:23], v[36:39], v[128:143]
    s_waitcnt lgkmcnt(0)
    s_barrier
    ds_read_b128 v[16:19], v6
    ds_read_b64_tr_b16 v[32:33], v14
    ds_read_b64_tr_b16 v[34:35], v14 offset:1280
    ds_read_b64_tr_b16 v[36:37], v14 offset:64
    ds_read_b64_tr_b16 v[38:39], v14 offset:1344
    v_mfma_f32_32x32x16_bf16 v[144:159], v[20:23], v[40:43], v[144:159]
    ds_read_b64_tr_b16 v[40:41], v14 offset:128
    ds_read_b64_tr_b16 v[42:43], v14 offset:1408
    v_mfma_f32_32x32x16_bf16 v[208:223], v[20:23], v[44:47], v[208:223]
    ds_read_b64_tr_b16 v[44:45], v14 offset:192
    ds_read_b64_tr_b16 v[46:47], v14 offset:1472
    v_mfma_f32_32x32x16_bf16 v[224:239], v[20:23], v[48:51], v[224:239]
    ds_read_b64_tr_b16 v[48:49], v14 offset:256
    ds_read_b64_tr_b16 v[50:51], v14 offset:1536
    ds_read_b128 v[20:23], v7
    s_waitcnt lgkmcnt(9)
    v_mfma_f32_32x32x16_bf16 v[112:127], v[16:19], v[32:35], v[112:127]
    ds_read_b64_tr_b16 v[32:33], v14 offset:5120
    ds_read_b64_tr_b16 v[34:35], v14 offset:6400
    s_waitcnt lgkmcnt(9)
    v_mfma_f32_32x32x16_bf16 v[128:143], v[16:19], v[36:39], v[128:143]
    ds_read_b64_tr_b16 v[36:37], v14 offset:5184
    ds_read_b64_tr_b16 v[38:39], v14 offset:6464
    s_waitcnt lgkmcnt(9)
    v_mfma_f32_32x32x16_bf16 v[144:159], v[16:19], v[40:43], v[144:159]
    ds_read_b64_tr_b16 v[40:41], v14 offset:5248
    ds_read_b64_tr_b16 v[42:43], v14 offset:6528
    s_waitcnt lgkmcnt(9)
    v_mfma_f32_32x32x16_bf16 v[208:223], v[16:19], v[44:47], v[208:223]
    ds_read_b64_tr_b16 v[44:45], v14 offset:5312
    ds_read_b64_tr_b16 v[46:47], v14 offset:6592
    s_waitcnt lgkmcnt(9)
    v_mfma_f32_32x32x16_bf16 v[224:239], v[16:19], v[48:51], v[224:239]
    ds_read_b64_tr_b16 v[48:49], v14 offset:5376
    ds_read_b64_tr_b16 v[50:51], v14 offset:6656
    ds_read_b128 v[16:19], v8
    s_waitcnt lgkmcnt(9)
    v_mfma_f32_32x32x16_bf16 v[112:127], v[20:23], v[32:35], v[112:127]
    ds_read_b64_tr_b16 v[32:33], v14 offset:10240
    ds_read_b64_tr_b16 v[34:35], v14 offset:11520
    s_waitcnt lgkmcnt(9)
    v_mfma_f32_32x32x16_bf16 v[128:143], v[20:23], v[36:39], v[128:143]
    ds_read_b64_tr_b16 v[36:37], v14 offset:10304
    ds_read_b64_tr_b16 v[38:39], v14 offset:11584
    s_waitcnt lgkmcnt(9)
    v_mfma_f32_32x32x16_bf16 v[144:159], v[20:23], v[40:43], v[144:159]
    ds_read_b64_tr_b16 v[40:41], v14 offset:10368
    ds_read_b64_tr_b16 v[42:43], v14 offset:11648
    s_waitcnt lgkmcnt(9)
    v_mfma_f32_32x32x16_bf16 v[208:223], v[20:23], v[44:47], v[208:223]
    ds_read_b64_tr_b16 v[44:45], v14 offset:10432
    ds_read_b64_tr_b16 v[46:47], v14 offset:11712
    s_waitcnt lgkmcnt(9)
    v_mfma_f32_32x32x16_bf16 v[224:239], v[20:23], v[48:51], v[224:239]
    ds_read_b64_tr_b16 v[48:49], v14 offset:10496
    ds_read_b64_tr_b16 v[50:51], v14 offset:11776
    ds_read_b128 v[20:23], v9
    s_waitcnt lgkmcnt(9)
    v_mfma_f32_32x32x16_bf16 v[112:127], v[16:19], v[32:35], v[112:127]
    ds_read_b64_tr_b16 v[32:33], v14 offset:15360
    ds_read_b64_tr_b16 v[34:35], v14 offset:16640
    s_waitcnt lgkmcnt(9)
    v_mfma_f32_32x32x16_bf16 v[128:143], v[16:19], v[36:39], v[128:143]
    ds_read_b64_tr_b16 v[36:37], v14 offset:15424
    ds_read_b64_tr_b16 v[38:39], v14 offset:16704
    s_waitcnt lgkmcnt(9)
    v_mfma_f32_32x32x16_bf16 v[144:159], v[16:19], v[40:43], v[144:159]
    ds_read_b64_tr_b16 v[40:41], v14 offset:15488
    ds_read_b64_tr_b16 v[42:43], v14 offset:16768
    s_waitcnt lgkmcnt(9)
    v_mfma_f32_32x32x16_bf16 v[208:223], v[16:19], v[44:47], v[208:223]
    ds_read_b64_tr_b16 v[44:45], v14 offset:15552
    ds_read_b64_tr_b16 v[46:47], v14 offset:16832
    s_waitcnt lgkmcnt(9)
    v_mfma_f32_32x32x16_bf16 v[224:239], v[16:19], v[48:51], v[224:239]
    ds_read_b64_tr_b16 v[48:49], v14 offset:15616
    ds_read_b64_tr_b16 v[50:51], v14 offset:16896
    s_mov_b32 s50, 0
    s_waitcnt vmcnt(0)
    s_branch L_chkP2_c
L_chkP2:
    buffer_load_dwordx4 v[24:27], v31, s[32:35], s53 offen sc1
    buffer_load_dwordx4 v[200:203], v31, s[32:35], s53 offen offset:1024 sc1
    buffer_load_dwordx4 v[204:207], v31, s[32:35], s53 offen offset:2048 sc1
    buffer_load_dwordx4 v[52:55], v31, s[32:35], s53 offen offset:3072 sc1
    s_waitcnt vmcnt(0)
L_chkP2_c:
    v_xor_b32 v28, s47, v25
    v_xor_b32 v29, s47, v27
    v_or_b32 v28, v28, v29
    v_xor_b32 v29, s47, v201
    v_or_b32 v28, v28, v29
    v_xor_b32 v29, s47, v203
    v_or_b32 v28, v28, v29
    v_xor_b32 v29, s47, v205
    v_or_b32 v28, v28, v29
    v_xor_b32 v29, s47, v207
    v_or_b32 v28, v28, v29
    v_xor_b32 v29, s47, v53
    v_or_b32 v28, v28, v29
    v_xor_b32 v29, s47, v55
    v_or_b32 v28, v28, v29
    v_cmp_ne_u32 vcc, 0, v28
    s_add_u32 s50, s50, 1
    s_cmp_gt_u32 s50, 200000
    s_cbranch_scc1 L_chkP2_d
    s_nop 0
    s_cmp_lg_u64 vcc, 0
    s_cbranch_scc1 L_chkP2
L_chkP2_d:
    v_mov_b32 v248, v24
    v_mov_b32 v249, v26
    v_mov_b32 v250, v200
    v_mov_b32 v251, v202
    v_mov_b32 v252, v204
    v_mov_b32 v253, v206
    v_mov_b32 v254, v52
    v_mov_b32 v255, v54
    s_waitcnt lgkmcnt(8)
    v_mfma_f32_32x32x16_bf16 v[112:127], v[20:23], v[32:35], v[112:127]
    s_waitcnt lgkmcnt(6)
    v_mfma_f32_32x32x16_bf16 v[128:143], v[20:23], v[36:39], v[128:143]
    s_waitcnt lgkmcnt(0)
    s_barrier
    ds_read_b128 v[16:19], v10 offset:40960
    ds_read_b64_tr_b16 v[32:33], v15 offset:40960
    ds_read_b64_tr_b16 v[34:35], v15 offset:42240
    ds_read_b64_tr_b16 v[36:37], v15 offset:41024
    ds_read_b64_tr_b16 v[38:39], v15 offset:42304
    v_mfma_f32_32x32x16_bf16 v[144:159], v[20:23], v[40:43], v[144:159]
    ds_read_b64_tr_b16 v[40:41], v15 offset:41088
    ds_read_b64_tr_b16 v[42:43], v15 offset:42368
    v_mfma_f32_32x32x16_bf16 v[208:223], v[20:23], v[44:47], v[208:223]
    ds_read_b64_tr_b16 v[44:45], v15 offset:41152
    ds_read_b64_tr_b16 v[46:47], v15 offset:42432
    v_mfma_f32_32x32x16_bf16 v[224:239], v[20:23], v[48:51], v[224:239]
    ds_read_b64_tr_b16 v[48:49], v15 offset:41216
    ds_read_b64_tr_b16 v[50:51], v15 offset:42496
    v_cvt_pk_bf16_f32 v112, v112, v113
    v_cvt_pk_bf16_f32 v113, v114, v115
    v_cvt_pk_bf16_f32 v114, v116, v117
    v_cvt_pk_bf16_f32 v115, v118, v119
    v_cvt_pk_bf16_f32 v116, v120, v121
    v_cvt_pk_bf16_f32 v117, v122, v123
    v_cvt_pk_bf16_f32 v118, v124, v125
    v_cvt_pk_bf16_f32 v119, v126, v127
    v_mfma_f32_32x32x16_bf16 v[64:79], v[112:115], v[248:251], v[64:79]
    s_nop 0
    v_mfma_f32_32x32x16_bf16 v[64:79], v[116:119], v[252:255], v[64:79]
    v_cvt_pk_bf16_f32 v128, v128, v129
    v_cvt_pk_bf16_f32 v129, v130, v131
    v_cvt_pk_bf16_f32 v130, v132, v133
    v_cvt_pk_bf16_f32 v131, v134, v135
    v_cvt_pk_bf16_f32 v132, v136, v137
    v_cvt_pk_bf16_f32 v133, v138, v139
    v_cvt_pk_bf16_f32 v134, v140, v141
    v_cvt_pk_bf16_f32 v135, v142, v143
    v_mfma_f32_32x32x16_bf16 v[80:95], v[128:131], v[248:251], v[80:95]
    s_nop 0
    v_mfma_f32_32x32x16_bf16 v[80:95], v[132:135], v[252:255], v[80:95]
    v_cvt_pk_bf16_f32 v144, v144, v145
    v_cvt_pk_bf16_f32 v145, v146, v147
    v_cvt_pk_bf16_f32 v146, v148, v149
    v_cvt_pk_bf16_f32 v147, v150, v151
    v_cvt_pk_bf16_f32 v148, v152, v153
    v_cvt_pk_bf16_f32 v149, v154, v155
    v_cvt_pk_bf16_f32 v150, v156, v157
    v_cvt_pk_bf16_f32 v151, v158, v159
    v_mfma_f32_32x32x16_bf16 v[96:111], v[144:147], v[248:251], v[96:111]
    s_nop 0
    v_mfma_f32_32x32x16_bf16 v[96:111], v[148:151], v[252:255], v[96:111]
    v_cvt_pk_bf16_f32 v208, v208, v209
    v_cvt_pk_bf16_f32 v209, v210, v211
    v_cvt_pk_bf16_f32 v210, v212, v213
    v_cvt_pk_bf16_f32 v211, v214, v215
    v_cvt_pk_bf16_f32 v212, v216, v217
    v_cvt_pk_bf16_f32 v213, v218, v219
    v_cvt_pk_bf16_f32 v214, v220, v221
    v_cvt_pk_bf16_f32 v215, v222, v223
    v_mfma_f32_32x32x16_bf16 v[160:175], v[208:211], v[248:251], v[160:175]
    s_nop 0
    v_mfma_f32_32x32x16_bf16 v[160:175], v[212:215], v[252:255], v[160:175]
    v_cvt_pk_bf16_f32 v224, v224, v225
    v_cvt_pk_bf16_f32 v225, v226, v227
    v_cvt_pk_bf16_f32 v226, v228, v229
    v_cvt_pk_bf16_f32 v227, v230, v231
    v_cvt_pk_bf16_f32 v228, v232, v233
    v_cvt_pk_bf16_f32 v229, v234, v235
    v_cvt_pk_bf16_f32 v230, v236, v237
    v_cvt_pk_bf16_f32 v231, v238, v239
    v_mfma_f32_32x32x16_bf16 v[176:191], v[224:227], v[248:251], v[176:191]
    s_nop 0
    v_mfma_f32_32x32x16_bf16 v[176:191], v[228:231], v[252:255], v[176:191]
    ds_read_b128 v[20:23], v11 offset:40960
    s_waitcnt lgkmcnt(9)
    v_mfma_f32_32x32x16_bf16 v[112:127], v[16:19], v[32:35], 0
    ds_read_b64_tr_b16 v[32:33], v15 offset:46080
    ds_read_b64_tr_b16 v[34:35], v15 offset:47360
    s_waitcnt lgkmcnt(9)
    v_mfma_f32_32x32x16_bf16 v[128:143], v[16:19], v[36:39], 0
    ds_read_b64_tr_b16 v[36:37], v15 offset:46144
    ds_read_b64_tr_b16 v[38:39], v15 offset:47424
    s_waitcnt lgkmcnt(9)
    v_mfma_f32_32x32x16_bf16 v[144:159], v[16:19], v[40:43], 0
    ds_read_b64_tr_b16 v[40:41], v15 offset:46208
    ds_read_b64_tr_b16 v[42:43], v15 offset:47488
    s_waitcnt lgkmcnt(9)
    v_mfma_f32_32x32x16_bf16 v[208:223], v[16:19], v[44:47], 0
    ds_read_b64_tr_b16 v[44:45], v15 offset:46272
    ds_read_b64_tr_b16 v[46:47], v15 offset:47552
    s_waitcnt lgkmcnt(9)
    v_mfma_f32_32x32x16_bf16 v[224:239], v[16:19], v[48:51], 0
    ds_read_b64_tr_b16 v[48:49], v15 offset:46336
    ds_read_b64_tr_b16 v[50:51], v15 offset:47616
    ds_read_b128 v[16:19], v12 offset:40960
    s_waitcnt lgkmcnt(9)
    v_mfma_f32_32x32x16_bf16 v[112:127], v[20:23], v[32:35], v[112:127]
    ds_read_b64_tr_b16 v[32:33], v15 offset:51200
    ds_read_b64_tr_b16 v[34:35], v15 offset:52480
    s_waitcnt lgkmcnt(9)
    v_mfma_f32_32x32x16_bf16 v[128:143], v[20:23], v[36:39], v[128:143]
    ds_read_b64_tr_b16 v[36:37], v15 offset:51264
    ds_read_b64_tr_b16 v[38:39], v15 offset:52544
    s_waitcnt lgkmcnt(9)
    v_mfma_f32_32x32x16_bf16 v[144:159], v[20:23], v[40:43], v[144:159]
    ds_read_b64_tr_b16 v[40:41], v15 offset:51328
    ds_read_b64_tr_b16 v[42:43], v15 offset:52608
    s_waitcnt lgkmcnt(9)
    v_mfma_f32_32x32x16_bf16 v[208:223], v[20:23], v[44:47], v[208:223]
    ds_read_b64_tr_b16 v[44:45], v15 offset:51392
    ds_read_b64_tr_b16 v[46:47], v15 offset:52672
    s_waitcnt lgkmcnt(9)
    v_mfma_f32_32x32x16_bf16 v[224:239], v[20:23], v[48:51], v[224:239]
    ds_read_b64_tr_b16 v[48:49], v15 offset:51456
    ds_read_b64_tr_b16 v[50:51], v15 offset:52736
    ds_read_b128 v[20:23], v13 offset:40960
    s_waitcnt lgkmcnt(9)
    v_mfma_f32_32x32x16_bf16 v[112:127], v[16:19], v[32:35], v[112:127]
    ds_read_b64_tr_b16 v[32:33], v15 offset:56320
    ds_read_b64_tr_b16 v[34:35], v15 offset:57600
    s_waitcnt lgkmcnt(9)
    v_mfma_f32_32x32x16_bf16 v[128:143], v[16:19], v[36:39], v[128:143]
    ds_read_b64_tr_b16 v[36:37], v15 offset:56384
    ds_read_b64_tr_b16 v[38:39], v15 offset:57664
    s_waitcnt lgkmcnt(9)
    v_mfma_f32_32x32x16_bf16 v[144:159], v[16:19], v[40:43], v[144:159]
    ds_read_b64_tr_b16 v[40:41], v15 offset:56448
    ds_read_b64_tr_b16 v[42:43], v15 offset:57728
    s_waitcnt lgkmcnt(9)
    v_mfma_f32_32x32x16_bf16 v[208:223], v[16:19], v[44:47], v[208:223]
    ds_read_b64_tr_b16 v[44:45], v15 offset:56512
    ds_read_b64_tr_b16 v[46:47], v15 offset:57792
    s_waitcnt lgkmcnt(9)
    v_mfma_f32_32x32x16_bf16 v[224:239], v[16:19], v[48:51], v[224:239]
    ds_read_b64_tr_b16 v[48:49], v15 offset:56576
    ds_read_b64_tr_b16 v[50:51], v15 offset:57856
    s_waitcnt lgkmcnt(8)
    v_mfma_f32_32x32x16_bf16 v[112:127], v[20:23], v[32:35], v[112:127]
    s_waitcnt lgkmcnt(6)
    v_mfma_f32_32x32x16_bf16 v[128:143], v[20:23], v[36:39], v[128:143]
    s_waitcnt lgkmcnt(0)
    s_barrier
    ds_read_b128 v[16:19], v6 offset:40960
    ds_read_b64_tr_b16 v[32:33], v14 offset:40960
    ds_read_b64_tr_b16 v[34:35], v14 offset:42240
    ds_read_b64_tr_b16 v[36:37], v14 offset:41024
    ds_read_b64_tr_b16 v[38:39], v14 offset:42304
    v_mfma_f32_32x32x16_bf16 v[144:159], v[20:23], v[40:43], v[144:159]
    ds_read_b64_tr_b16 v[40:41], v14 offset:41088
    ds_read_b64_tr_b16 v[42:43], v14 offset:42368
    v_mfma_f32_32x32x16_bf16 v[208:223], v[20:23], v[44:47], v[208:223]
    ds_read_b64_tr_b16 v[44:45], v14 offset:41152
    ds_read_b64_tr_b16 v[46:47], v14 offset:42432
    v_mfma_f32_32x32x16_bf16 v[224:239], v[20:23], v[48:51], v[224:239]
    ds_read_b64_tr_b16 v[48:49], v14 offset:41216
    ds_read_b64_tr_b16 v[50:51], v14 offset:42496
    s_add_u32 s3, s41, 3
    s_and_b32 s3, s3, 3
    s_lshl_b32 s3, s3, 14
    s_add_u32 s53, s3, s45
    buffer_load_dwordx4 v[24:27], v31, s[32:35], s53 offen sc1
    buffer_load_dwordx4 v[200:203], v31, s[32:35], s53 offen offset:1024 sc1
    buffer_load_dwordx4 v[204:207], v31, s[32:35], s53 offen offset:2048 sc1
    buffer_load_dwordx4 v[52:55], v31, s[32:35], s53 offen offset:3072 sc1
    ds_read_b128 v[20:23], v7 offset:40960
    s_waitcnt lgkmcnt(9)
    v_mfma_f32_32x32x16_bf16 v[112:127], v[16:19], v[32:35], v[112:127]
    ds_read_b64_tr_b16 v[32:33], v14 offset:46080
    ds_read_b64_tr_b16 v[34:35], v14 offset:47360
    s_waitcnt lgkmcnt(9)
    v_mfma_f32_32x32x16_bf16 v[128:143], v[16:19], v[36:39], v[128:143]
    ds_read_b64_tr_b16 v[36:37], v14 offset:46144
    ds_read_b64_tr_b16 v[38:39], v14 offset:47424
    s_waitcnt lgkmcnt(9)
    v_mfma_f32_32x32x16_bf16 v[144:159], v[16:19], v[40:43], v[144:159]
    ds_read_b64_tr_b16 v[40:41], v14 offset:46208
    ds_read_b64_tr_b16 v[42:43], v14 offset:47488
    s_waitcnt lgkmcnt(9)
    v_mfma_f32_32x32x16_bf16 v[208:223], v[16:19], v[44:47], v[208:223]
    ds_read_b64_tr_b16 v[44:45], v14 offset:46272
    ds_read_b64_tr_b16 v[46:47], v14 offset:47552
    s_waitcnt lgkmcnt(9)
    v_mfma_f32_32x32x16_bf16 v[224:239], v[16:19], v[48:51], v[224:239]
    ds_read_b64_tr_b16 v[48:49], v14 offset:46336
    ds_read_b64_tr_b16 v[50:51], v14 offset:47616
    ds_read_b128 v[16:19], v8 offset:40960
    s_waitcnt lgkmcnt(9)
    v_mfma_f32_32x32x16_bf16 v[112:127], v[20:23], v[32:35], v[112:127]
    ds_read_b64_tr_b16 v[32:33], v14 offset:51200
    ds_read_b64_tr_b16 v[34:35], v14 offset:52480
    s_waitcnt lgkmcnt(9)
    v_mfma_f32_32x32x16_bf16 v[128:143], v[20:23], v[36:39], v[128:143]
    ds_read_b64_tr_b16 v[36:37], v14 offset:51264
    ds_read_b64_tr_b16 v[38:39], v14 offset:52544
    s_waitcnt lgkmcnt(9)
    v_mfma_f32_32x32x16_bf16 v[144:159], v[20:23], v[40:43], v[144:159]
    ds_read_b64_tr_b16 v[40:41], v14 offset:51328
    ds_read_b64_tr_b16 v[42:43], v14 offset:52608
    s_waitcnt lgkmcnt(9)
    v_mfma_f32_32x32x16_bf16 v[208:223], v[20:23], v[44:47], v[208:223]
    ds_read_b64_tr_b16 v[44:45], v14 offset:51392
    ds_read_b64_tr_b16 v[46:47], v14 offset:52672
    s_waitcnt lgkmcnt(9)
    v_mfma_f32_32x32x16_bf16 v[224:239], v[20:23], v[48:51], v[224:239]
    ds_read_b64_tr_b16 v[48:49], v14 offset:51456
    ds_read_b64_tr_b16 v[50:51], v14 offset:52736
    ds_read_b128 v[20:23], v9 offset:40960
    s_waitcnt lgkmcnt(9)
    v_mfma_f32_32x32x16_bf16 v[112:127], v[16:19], v[32:35], v[112:127]
    ds_read_b64_tr_b16 v[32:33], v14 offset:56320
    ds_read_b64_tr_b16 v[34:35], v14 offset:57600
    s_waitcnt lgkmcnt(9)
    v_mfma_f32_32x32x16_bf16 v[128:143], v[16:19], v[36:39], v[128:143]
    ds_read_b64_tr_b16 v[36:37], v14 offset:56384
    ds_read_b64_tr_b16 v[38:39], v14 offset:57664
    s_waitcnt lgkmcnt(9)
    v_mfma_f32_32x32x16_bf16 v[144:159], v[16:19], v[40:43], v[144:159]
    ds_read_b64_tr_b16 v[40:41], v14 offset:56448
    ds_read_b64_tr_b16 v[42:43], v14 offset:57728
    s_waitcnt lgkmcnt(9)
    v_mfma_f32_32x32x16_bf16 v[208:223], v[16:19], v[44:47], v[208:223]
    ds_read_b64_tr_b16 v[44:45], v14 offset:56512
    ds_read_b64_tr_b16 v[46:47], v14 offset:57792
    s_waitcnt lgkmcnt(9)
    v_mfma_f32_32x32x16_bf16 v[224:239], v[16:19], v[48:51], v[224:239]
    ds_read_b64_tr_b16 v[48:49], v14 offset:56576
    ds_read_b64_tr_b16 v[50:51], v14 offset:57856
    s_waitcnt lgkmcnt(8)
    v_mfma_f32_32x32x16_bf16 v[112:127], v[20:23], v[32:35], v[112:127]
    s_waitcnt lgkmcnt(6)
    v_mfma_f32_32x32x16_bf16 v[128:143], v[20:23], v[36:39], v[128:143]
    s_waitcnt lgkmcnt(0)
    s_barrier
    ds_read_b128 v[16:19], v10
    ds_read_b64_tr_b16 v[32:33], v15
    ds_read_b64_tr_b16 v[34:35], v15 offset:1280
    ds_read_b64_tr_b16 v[36:37], v15 offset:64
    ds_read_b64_tr_b16 v[38:39], v15 offset:1344
    v_mfma_f32_32x32x16_bf16 v[144:159], v[20:23], v[40:43], v[144:159]
    ds_read_b64_tr_b16 v[40:41], v15 offset:128
    ds_read_b64_tr_b16 v[42:43], v15 offset:1408
    v_mfma_f32_32x32x16_bf16 v[208:223], v[20:23], v[44:47], v[208:223]
    ds_read_b64_tr_b16 v[44:45], v15 offset:192
    ds_read_b64_tr_b16 v[46:47], v15 offset:1472
    v_mfma_f32_32x32x16_bf16 v[224:239], v[20:23], v[48:51], v[224:239]
    ds_read_b64_tr_b16 v[48:49], v15 offset:256
    ds_read_b64_tr_b16 v[50:51], v15 offset:1536
    ds_read_b128 v[20:23], v11
    s_waitcnt lgkmcnt(9)
    v_mfma_f32_32x32x16_bf16 v[112:127], v[16:19], v[32:35], v[112:127]
    ds_read_b64_tr_b16 v[32:33], v15 offset:5120
    ds_read_b64_tr_b16 v[34:35], v15 offset:6400
    s_waitcnt lgkmcnt(9)
    v_mfma_f32_32x32x16_bf16 v[128:143], v[16:19], v[36:39], v[128:143]
    ds_read_b64_tr_b16 v[36:37], v15 offset:5184
    ds_read_b64_tr_b16 v[38:39], v15 offset:6464
    s_waitcnt lgkmcnt(9)
    v_mfma_f32_32x32x16_bf16 v[144:159], v[16:19], v[40:43], v[144:159]
    ds_read_b64_tr_b16 v[40:41], v15 offset:5248
    ds_read_b64_tr_b16 v[42:43], v15 offset:6528
    s_waitcnt lgkmcnt(9)
    v_mfma_f32_32x32x16_bf16 v[208:223], v[16:19], v[44:47], v[208:223]
    ds_read_b64_tr_b16 v[44:45], v15 offset:5312
    ds_read_b64_tr_b16 v[46:47], v15 offset:6592
    s_waitcnt lgkmcnt(9)
    v_mfma_f32_32x32x16_bf16 v[224:239], v[16:19], v[48:51], v[224:239]
    ds_read_b64_tr_b16 v[48:49], v15 offset:5376
    ds_read_b64_tr_b16 v[50:51], v15 offset:6656
    ds_read_b128 v[16:19], v12
    s_waitcnt lgkmcnt(9)
    v_mfma_f32_32x32x16_bf16 v[112:127], v[20:23], v[32:35], v[112:127]
    ds_read_b64_tr_b16 v[32:33], v15 offset:10240
    ds_read_b64_tr_b16 v[34:35], v15 offset:11520
    s_waitcnt lgkmcnt(9)
    v_mfma_f32_32x32x16_bf16 v[128:143], v[20:23], v[36:39], v[128:143]
    ds_read_b64_tr_b16 v[36:37], v15 offset:10304
    ds_read_b64_tr_b16 v[38:39], v15 offset:11584
    s_waitcnt lgkmcnt(9)
    v_mfma_f32_32x32x16_bf16 v[144:159], v[20:23], v[40:43], v[144:159]
    ds_read_b64_tr_b16 v[40:41], v15 offset:10368
    ds_read_b64_tr_b16 v[42:43], v15 offset:11648
    s_waitcnt lgkmcnt(9)
    v_mfma_f32_32x32x16_bf16 v[208:223], v[20:23], v[44:47], v[208:223]
    ds_read_b64_tr_b16 v[44:45], v15 offset:10432
    ds_read_b64_tr_b16 v[46:47], v15 offset:11712
    s_waitcnt lgkmcnt(9)
    v_mfma_f32_32x32x16_bf16 v[224:239], v[20:23], v[48:51], v[224:239]
    ds_read_b64_tr_b16 v[48:49], v15 offset:10496
    ds_read_b64_tr_b16 v[50:51], v15 offset:11776
    ds_read_b128 v[20:23], v13
    s_waitcnt lgkmcnt(9)
    v_mfma_f32_32x32x16_bf16 v[112:127], v[16:19], v[32:35], v[112:127]
    ds_read_b64_tr_b16 v[32:33], v15 offset:15360
    ds_read_b64_tr_b16 v[34:35], v15 offset:16640
    s_waitcnt lgkmcnt(9)
    v_mfma_f32_32x32x16_bf16 v[128:143], v[16:19], v[36:39], v[128:143]
    ds_read_b64_tr_b16 v[36:37], v15 offset:15424
    ds_read_b64_tr_b16 v[38:39], v15 offset:16704
    s_waitcnt lgkmcnt(9)
    v_mfma_f32_32x32x16_bf16 v[144:159], v[16:19], v[40:43], v[144:159]
    ds_read_b64_tr_b16 v[40:41], v15 offset:15488
    ds_read_b64_tr_b16 v[42:43], v15 offset:16768
    s_waitcnt lgkmcnt(9)
    v_mfma_f32_32x32x16_bf16 v[208:223], v[16:19], v[44:47], v[208:223]
    ds_read_b64_tr_b16 v[44:45], v15 offset:15552
    ds_read_b64_tr_b16 v[46:47], v15 offset:16832
    s_waitcnt lgkmcnt(9)
    v_mfma_f32_32x32x16_bf16 v[224:239], v[16:19], v[48:51], v[224:239]
    ds_read_b64_tr_b16 v[48:49], v15 offset:15616
    ds_read_b64_tr_b16 v[50:51], v15 offset:16896
    s_mov_b32 s50, 0
    s_waitcnt vmcnt(0)
    s_branch L_chkP3_c
L_chkP3:
    buffer_load_dwordx4 v[24:27], v31, s[32:35], s53 offen sc1
    buffer_load_dwordx4 v[200:203], v31, s[32:35], s53 offen offset:1024 sc1
    buffer_load_dwordx4 v[204:207], v31, s[32:35], s53 offen offset:2048 sc1
    buffer_load_dwordx4 v[52:55], v31, s[32:35], s53 offen offset:3072 sc1
    s_waitcnt vmcnt(0)
L_chkP3_c:
    v_xor_b32 v28, s47, v25
    v_xor_b32 v29, s47, v27
    v_or_b32 v28, v28, v29
    v_xor_b32 v29, s47, v201
    v_or_b32 v28, v28, v29
    v_xor_b32 v29, s47, v203
    v_or_b32 v28, v28, v29
    v_xor_b32 v29, s47, v205
    v_or_b32 v28, v28, v29
    v_xor_b32 v29, s47, v207
    v_or_b32 v28, v28, v29
    v_xor_b32 v29, s47, v53
    v_or_b32 v28, v28, v29
    v_xor_b32 v29, s47, v55
    v_or_b32 v28, v28, v29
    v_cmp_ne_u32 vcc, 0, v28
    s_add_u32 s50, s50, 1
    s_cmp_gt_u32 s50, 200000
    s_cbranch_scc1 L_chkP3_d
    s_nop 0
    s_cmp_lg_u64 vcc, 0
    s_cbranch_scc1 L_chkP3
L_chkP3_d:
    v_mov_b32 v192, v24
    v_mov_b32 v193, v26
    v_mov_b32 v194, v200
    v_mov_b32 v195, v202
    v_mov_b32 v196, v204
    v_mov_b32 v197, v206
    v_mov_b32 v198, v52
    v_mov_b32 v199, v54
    s_waitcnt lgkmcnt(8)
    v_mfma_f32_32x32x16_bf16 v[112:127], v[20:23], v[32:35], v[112:127]
    s_waitcnt lgkmcnt(6)
    v_mfma_f32_32x32x16_bf16 v[128:143], v[20:23], v[36:39], v[128:143]
    s_waitcnt lgkmcnt(4)
    v_mfma_f32_32x32x16_bf16 v[144:159], v[20:23], v[40:43], v[144:159]
    s_waitcnt lgkmcnt(2)
    v_mfma_f32_32x32x16_bf16 v[208:223], v[20:23], v[44:47], v[208:223]
    s_waitcnt lgkmcnt(0)
    v_mfma_f32_32x32x16_bf16 v[224:239], v[20:23], v[48:51], v[224:239]
    s_nop 3
    v_cvt_pk_bf16_f32 v112, v112, v113
    v_cvt_pk_bf16_f32 v113, v114, v115
    v_cvt_pk_bf16_f32 v114, v116, v117
    v_cvt_pk_bf16_f32 v115, v118, v119
    v_cvt_pk_bf16_f32 v116, v120, v121
    v_cvt_pk_bf16_f32 v117, v122, v123
    v_cvt_pk_bf16_f32 v118, v124, v125
    v_cvt_pk_bf16_f32 v119, v126, v127
    v_mfma_f32_32x32x16_bf16 v[64:79], v[112:115], v[192:195], v[64:79]
    s_nop 0
    v_mfma_f32_32x32x16_bf16 v[64:79], v[116:119], v[196:199], v[64:79]
    v_cvt_pk_bf16_f32 v128, v128, v129
    v_cvt_pk_bf16_f32 v129, v130, v131
    v_cvt_pk_bf16_f32 v130, v132, v133
    v_cvt_pk_bf16_f32 v131, v134, v135
    v_cvt_pk_bf16_f32 v132, v136, v137
    v_cvt_pk_bf16_f32 v133, v138, v139
    v_cvt_pk_bf16_f32 v134, v140, v141
    v_cvt_pk_bf16_f32 v135, v142, v143
    v_mfma_f32_32x32x16_bf16 v[80:95], v[128:131], v[192:195], v[80:95]
    s_nop 0
    v_mfma_f32_32x32x16_bf16 v[80:95], v[132:135], v[196:199], v[80:95]
    s_nop 0
    v_cvt_pk_bf16_f32 v120, v64, v65
    v_cvt_pk_bf16_f32 v121, v66, v67
    v_cvt_pk_bf16_f32 v122, v68, v69
    v_cvt_pk_bf16_f32 v123, v70, v71
    v_cvt_pk_bf16_f32 v124, v72, v73
    v_cvt_pk_bf16_f32 v125, v74, v75
    v_cvt_pk_bf16_f32 v126, v76, v77
    v_cvt_pk_bf16_f32 v127, v78, v79
    buffer_store_dwordx4 v[120:123], v31, s[32:35], s52 offen sc1
    buffer_store_dwordx4 v[124:127], v31, s[32:35], s52 offen offset:1024 sc1
    v_cvt_pk_bf16_f32 v144, v144, v145
    v_cvt_pk_bf16_f32 v145, v146, v147
    v_cvt_pk_bf16_f32 v146, v148, v149
    v_cvt_pk_bf16_f32 v147, v150, v151
    v_cvt_pk_bf16_f32 v148, v152, v153
    v_cvt_pk_bf16_f32 v149, v154, v155
    v_cvt_pk_bf16_f32 v150, v156, v157
    v_cvt_pk_bf16_f32 v151, v158, v159
    v_mfma_f32_32x32x16_bf16 v[96:111], v[144:147], v[192:195], v[96:111]
    s_nop 0
    v_mfma_f32_32x32x16_bf16 v[96:111], v[148:151], v[196:199], v[96:111]
    v_cvt_pk_bf16_f32 v136, v80, v81
    v_cvt_pk_bf16_f32 v137, v82, v83
    v_cvt_pk_bf16_f32 v138, v84, v85
    v_cvt_pk_bf16_f32 v139, v86, v87
    v_cvt_pk_bf16_f32 v140, v88, v89
    v_cvt_pk_bf16_f32 v141, v90, v91
    v_cvt_pk_bf16_f32 v142, v92, v93
    v_cvt_pk_bf16_f32 v143, v94, v95
    buffer_store_dwordx4 v[136:139], v31, s[32:35], s52 offen offset:2048 sc1
    buffer_store_dwordx4 v[140:143], v31, s[32:35], s52 offen offset:3072 sc1
    v_cvt_pk_bf16_f32 v208, v208, v209
    v_cvt_pk_bf16_f32 v209, v210, v211
    v_cvt_pk_bf16_f32 v210, v212, v213
    v_cvt_pk_bf16_f32 v211, v214, v215
    v_cvt_pk_bf16_f32 v212, v216, v217
    v_cvt_pk_bf16_f32 v213, v218, v219
    v_cvt_pk_bf16_f32 v214, v220, v221
    v_cvt_pk_bf16_f32 v215, v222, v223
    v_mfma_f32_32x32x16_bf16 v[160:175], v[208:211], v[192:195], v[160:175]
    s_nop 0
    v_mfma_f32_32x32x16_bf16 v[160:175], v[212:215], v[196:199], v[160:175]
    v_cvt_pk_bf16_f32 v152, v96, v97
    v_cvt_pk_bf16_f32 v153, v98, v99
    v_cvt_pk_bf16_f32 v154, v100, v101
    v_cvt_pk_bf16_f32 v155, v102, v103
    v_cvt_pk_bf16_f32 v156, v104, v105
    v_cvt_pk_bf16_f32 v157, v106, v107
    v_cvt_pk_bf16_f32 v158, v108, v109
    v_cvt_pk_bf16_f32 v159, v110, v111
    s_add_u32 s46, s52, 0x1000
    buffer_store_dwordx4 v[152:155], v31, s[32:35], s46 offen sc1
    s_add_u32 s46, s52, 0x1000
    buffer_store_dwordx4 v[156:159], v31, s[32:35], s46 offen offset:1024 sc1
    v_cvt_pk_bf16_f32 v224, v224, v225
    v_cvt_pk_bf16_f32 v225, v226, v227
    v_cvt_pk_bf16_f32 v226, v228, v229
    v_cvt_pk_bf16_f32 v227, v230, v231
    v_cvt_pk_bf16_f32 v228, v232, v233
    v_cvt_pk_bf16_f32 v229, v234, v235
    v_cvt_pk_bf16_f32 v230, v236, v237
    v_cvt_pk_bf16_f32 v231, v238, v239
    v_mfma_f32_32x32x16_bf16 v[176:191], v[224:227], v[192:195], v[176:191]
    s_nop 0
    v_mfma_f32_32x32x16_bf16 v[176:191], v[228:231], v[196:199], v[176:191]
    v_cvt_pk_bf16_f32 v216, v160, v161
    v_cvt_pk_bf16_f32 v217, v162, v163
    v_cvt_pk_bf16_f32 v218, v164, v165
    v_cvt_pk_bf16_f32 v219, v166, v167
    v_cvt_pk_bf16_f32 v220, v168, v169
    v_cvt_pk_bf16_f32 v221, v170, v171
    v_cvt_pk_bf16_f32 v222, v172, v173
    v_cvt_pk_bf16_f32 v223, v174, v175
    s_add_u32 s46, s52, 0x1000
    buffer_store_dwordx4 v[216:219], v31, s[32:35], s46 offen offset:2048 sc1
    s_add_u32 s46, s52, 0x1000
    buffer_store_dwordx4 v[220:223], v31, s[32:35], s46 offen offset:3072 sc1
    v_cvt_pk_bf16_f32 v232, v176, v177
    v_cvt_pk_bf16_f32 v233, v178, v179
    v_cvt_pk_bf16_f32 v234, v180, v181
    v_cvt_pk_bf16_f32 v235, v182, v183
    v_cvt_pk_bf16_f32 v236, v184, v185
    v_cvt_pk_bf16_f32 v237, v186, v187
    v_cvt_pk_bf16_f32 v238, v188, v189
    v_cvt_pk_bf16_f32 v239, v190, v191
    s_add_u32 s46, s52, 0x2000
    buffer_store_dwordx4 v[232:235], v31, s[32:35], s46 offen sc1
    s_add_u32 s46, s52, 0x2000
    buffer_store_dwordx4 v[236:239], v31, s[32:35], s46 offen offset:1024 sc1
    s_barrier
    s_waitcnt vmcnt(0)
    s_mov_b64 exec, 1
    v_mov_b32 v5, s47
    v_mov_b32 v6, 0
    buffer_store_dword v5, v6, s[32:35], s43 offen sc1
    s_mov_b64 exec, -1
    s_endpgm
L_end:
    s_endpgm
.section .rodata,"a"
.p2align 6
.amdhsa_kernel concat_heads__gqa_block_cached__mha_block_cached__near_ridge_kernel
  .amdhsa_next_free_vgpr 256
  .amdhsa_next_free_sgpr 102
  .amdhsa_accum_offset 256
  .amdhsa_group_segment_fixed_size 0
  .amdhsa_kernarg_size 104
  .amdhsa_user_sgpr_count 2
  .amdhsa_user_sgpr_kernarg_segment_ptr 1
  .amdhsa_system_sgpr_workgroup_id_x 1
.end_amdhsa_kernel
```
